```python
import torch

def _softmax(x, axis=-1):
    return torch.softmax(x, dim=axis)
def _gelu(x):
    return torch.nn.functional.gelu(x, approximate="tanh")
def _silu(x):
    return torch.nn.functional.silu(x)
def _sigmoid(x):
    return torch.sigmoid(x)
def _layernorm(x, axis=-1, eps=1e-5):
    m = x.mean(dim=axis, keepdim=True)
    v = x.var(dim=axis, keepdim=True, unbiased=False)
    return (x - m) / torch.sqrt(v + eps)
def _scatter_add(tgt, idx, src, axis=0):
    return tgt.clone().index_add_(axis, idx, src)
def _segment_sum(src, seg, n):
    out = torch.zeros((n,) + src.shape[1:], dtype=src.dtype)
    return out.index_add_(0, seg, src)
def _pad(x, pw):
    flat = tuple(v for pair in reversed(pw) for v in pair)
    return torch.nn.functional.pad(x, flat)

kernel_name = 'gather_scatter__hybrid_graph_tf_nagphormer__graph'

def setup_inputs():

    _w = (lambda a: (lambda t: t.to(torch.bfloat16) if t.is_floating_point() else t)(torch.as_tensor(a)))
    N, deg, D = 25000, 32, 64
    E = N * deg
    src = (lambda lo, hi, *s: torch.randint(lo, hi, s))(0, N, E).to(torch.int64)
    dst = (lambda lo, hi, *s: torch.randint(lo, hi, s))(0, N, E).to(torch.int64)
    deg_cnt = torch.bincount(dst, minlength=N).to(float) + 1.0
    sc = 1.0 / D ** 0.5
    return {
        "x": _w((lambda *s: torch.randn(*s, dtype=torch.bfloat16) * 0.1)(N, D)),
        "src": _w(src),
        "dst": _w(dst),
        "deg_inv_sqrt": _w(1.0 / (lambda _x: torch.sqrt(torch.as_tensor(_x)))(deg_cnt)),
        "wq": _w((lambda *s: torch.randn(*s, dtype=torch.bfloat16) * 1.6)(D, D) * sc),
        "wk": _w((lambda *s: torch.randn(*s, dtype=torch.bfloat16) * 3.2)(D, D) * sc),
        "wv": _w((lambda *s: torch.randn(*s, dtype=torch.bfloat16) * 0.1)(D, D) * sc),
        "wo": _w((lambda *s: torch.randn(*s, dtype=torch.bfloat16) * 0.1)(D, D) * sc),
        "w_r": _w((lambda *s: torch.randn(*s, dtype=torch.bfloat16) * 0.1)(D)),
    }

def reference(x, src, dst, deg_inv_sqrt, wq, wk, wv, wo, w_r):
    N, D = x.shape[0], x.shape[1]
    K = 7
    h = x
    toks = [x]
    for _ in range(K):
        msg = h[src] * deg_inv_sqrt[src, None] * deg_inv_sqrt[dst, None]
        h = _segment_sum(msg, dst, N)
        toks.append(h)
    tok = torch.stack(toks, axis=1)
    t = _layernorm(tok, axis=-1)
    q   = torch.einsum('nkd,de->nke', t, wq)
    key = torch.einsum('nkd,de->nke', t, wk)
    v   = torch.einsum('nkd,de->nke', t, wv)
    scale = 1.0 / (D ** 0.5)
    attn = _softmax(torch.einsum('nkd,nld->nkl', q, key) * scale, axis=-1)
    o = torch.einsum('nkl,nld->nkd', attn, v)
    o = tok + torch.einsum('nkd,de->nke', o, wo)
    r = _layernorm(o, axis=-1)
    alpha = _softmax(torch.einsum('nkd,d->nk', r, w_r), axis=-1)
    return torch.einsum('nk,nkd->nd', alpha, o)
```

```asm
; @launch kernel=bin_kernel grid=(251,1,1) block=(1024,1,1) lds=69536
; @launch kernel=graph_kernel grid=(250,1,1) block=(1024,1,1) lds=159952
.amdgcn_target "amdgcn-amd-amdhsa--gfx950"
.text
.globl bin_kernel
.p2align 8
.type bin_kernel,@function
bin_kernel:
s_cmp_gt_u32 s2, 250
s_cbranch_scc1 K1_END
s_load_dwordx8 s[4:11], s[0:1], 0
s_load_dwordx2 s[12:13], s[0:1], 88
s_cmp_eq_u32 s2, 250
s_cbranch_scc1 K1_W
v_lshlrev_b32 v1, 4, v0
v_lshlrev_b32 v2, 2, v0
v_mov_b32 v3, 0
s_movk_i32 s14, 0x100
v_cmp_gt_u32 vcc, s14, v0
s_and_saveexec_b64 s[40:41], vcc
ds_write_b32 v2, v3
s_mov_b64 exec, s[40:41]
s_movk_i32 s14, 128
v_cmp_gt_u32 vcc, s14, v0
s_and_saveexec_b64 s[40:41], vcc
v_mov_b32 v3, -1
v_add_u32 v5, 69024, v2
ds_write_b32 v5, v3
s_mov_b64 exec, s[40:41]
s_movk_i32 s14, 800
v_cmp_gt_u32 vcc, s14, v0
s_mov_b64 s[42:43], vcc
s_mul_i32 s14, s2, 12800
s_mul_i32 s15, s2, 200
s_movk_i32 s47, 272
v_lshrrev_b32 v4, 3, v0
v_lshlrev_b32 v4, 1, v4
s_waitcnt lgkmcnt(0)
s_mov_b32 s16, s6
s_mov_b32 s17, s7
s_mov_b32 s18, 3200000
s_mov_b32 s19, 0x00020000
s_mov_b32 s20, s8
s_mov_b32 s21, s9
s_mov_b32 s22, 3200000
s_mov_b32 s23, 0x00020000
s_mov_b32 s24, s4
s_mov_b32 s25, s5
s_mov_b32 s26, 3200000
s_mov_b32 s27, 0x00020000
s_mov_b32 s28, s10
s_mov_b32 s29, s11
s_mov_b32 s30, 50000
s_mov_b32 s31, 0x00020000
s_mov_b32 s32, s12
s_mov_b32 s33, s13
s_mov_b32 s34, 0x8000000
s_mov_b32 s35, 0x00020000
s_mov_b64 exec, s[42:43]
s_cbranch_execz K1_NOLD
buffer_load_dwordx4 v[8:11], v1, s[20:23], s14 offen
buffer_load_dwordx4 v[12:15], v1, s[16:19], s14 offen
buffer_load_dwordx4 v[16:19], v1, s[24:27], s14 offen
buffer_load_ushort v20, v4, s[28:31], s15 offen
v_mov_b32 v24, -1
v_mov_b32 v25, -1
v_mov_b32 v26, -1
v_mov_b32 v27, -1
K1_NOLD:
s_mov_b64 exec, -1
s_waitcnt lgkmcnt(0)
s_barrier
s_mov_b64 exec, s[42:43]
s_cbranch_execz K1_SKIP
s_waitcnt vmcnt(3)
s_movk_i32 s45, 5243
s_movk_i32 s46, -100
v_mov_b32 v21, 1
v_mul_u32_u24 v28, s45, v8
v_lshrrev_b32 v28, 19, v28
v_mad_i32_i24 v8, v28, s46, v8
v_lshlrev_b32 v22, 2, v28
ds_add_rtn_u32 v32, v22, v21
v_mul_u32_u24 v28, s47, v28
v_mul_u32_u24 v29, s45, v9
v_lshrrev_b32 v29, 19, v29
v_mad_i32_i24 v9, v29, s46, v9
v_lshlrev_b32 v22, 2, v29
ds_add_rtn_u32 v33, v22, v21
v_mul_u32_u24 v29, s47, v29
v_mul_u32_u24 v30, s45, v10
v_lshrrev_b32 v30, 19, v30
v_mad_i32_i24 v10, v30, s46, v10
v_lshlrev_b32 v22, 2, v30
ds_add_rtn_u32 v34, v22, v21
v_mul_u32_u24 v30, s47, v30
v_mul_u32_u24 v31, s45, v11
v_lshrrev_b32 v31, 19, v31
v_mad_i32_i24 v11, v31, s46, v11
v_lshlrev_b32 v22, 2, v31
ds_add_rtn_u32 v35, v22, v21
v_mul_u32_u24 v31, s47, v31
s_waitcnt vmcnt(2)
v_lshlrev_b32 v52, 1, v12
buffer_load_ushort v56, v52, s[28:31], 0 offen
v_lshlrev_b32 v53, 1, v13
buffer_load_ushort v57, v53, s[28:31], 0 offen
v_lshlrev_b32 v54, 1, v14
buffer_load_ushort v58, v54, s[28:31], 0 offen
v_lshlrev_b32 v55, 1, v15
buffer_load_ushort v59, v55, s[28:31], 0 offen
s_add_u32 s44, s14, 0xc00000
buffer_store_dwordx4 v[24:27], v1, s[32:35], s44 offen sc1
v_lshl_or_b32 v8, v8, 19, v12
v_lshl_or_b32 v9, v9, 19, v13
v_lshl_or_b32 v10, v10, 19, v14
v_lshl_or_b32 v11, v11, 19, v15
s_waitcnt vmcnt(5)
v_lshrrev_b32 v36, 3, v0
v_and_b32 v37, 7, v0
v_lshl_or_b32 v38, v20, 7, v36
v_lshlrev_b32 v39, 2, v36
v_add_u32 v39, 69024, v39
ds_write_b32 v39, v38
v_lshlrev_b32 v20, 16, v20
v_lshlrev_b32 v22, 16, v16
v_and_b32 v23, 0xffff0000, v16
v_mul_f32 v22, v22, v20
v_mul_f32 v23, v23, v20
v_cvt_pk_bf16_f32 v16, v22, v23
v_lshlrev_b32 v22, 16, v17
v_and_b32 v23, 0xffff0000, v17
v_mul_f32 v22, v22, v20
v_mul_f32 v23, v23, v20
v_cvt_pk_bf16_f32 v17, v22, v23
v_lshlrev_b32 v22, 16, v18
v_and_b32 v23, 0xffff0000, v18
v_mul_f32 v22, v22, v20
v_mul_f32 v23, v23, v20
v_cvt_pk_bf16_f32 v18, v22, v23
v_lshlrev_b32 v22, 16, v19
v_and_b32 v23, 0xffff0000, v19
v_mul_f32 v22, v22, v20
v_mul_f32 v23, v23, v20
v_cvt_pk_bf16_f32 v19, v22, v23
s_add_u32 s44, s14, 0x800000
buffer_store_dwordx4 v[16:19], v1, s[32:35], s44 offen sc1
s_waitcnt lgkmcnt(0)
s_barrier
v_lshlrev_b32 v39, 6, v37
v_add_u32 v39, 69024, v39
ds_read_b128 v[64:67], v39 offset:0
ds_read_b128 v[68:71], v39 offset:16
ds_read_b128 v[72:75], v39 offset:32
ds_read_b128 v[76:79], v39 offset:48
v_mov_b32 v40, 0
v_mov_b32 v41, 0
s_waitcnt lgkmcnt(0)
v_cmp_lt_u32 s[56:57], v64, v38
v_cmp_lt_u32 s[58:59], v65, v38
v_cmp_lt_u32 s[60:61], v66, v38
v_cmp_lt_u32 s[62:63], v67, v38
v_addc_co_u32 v40, s[56:57], 0, v40, s[56:57]
v_addc_co_u32 v41, s[58:59], 0, v41, s[58:59]
v_addc_co_u32 v40, s[60:61], 0, v40, s[60:61]
v_addc_co_u32 v41, s[62:63], 0, v41, s[62:63]
v_cmp_lt_u32 s[56:57], v68, v38
v_cmp_lt_u32 s[58:59], v69, v38
v_cmp_lt_u32 s[60:61], v70, v38
v_cmp_lt_u32 s[62:63], v71, v38
v_addc_co_u32 v40, s[56:57], 0, v40, s[56:57]
v_addc_co_u32 v41, s[58:59], 0, v41, s[58:59]
v_addc_co_u32 v40, s[60:61], 0, v40, s[60:61]
v_addc_co_u32 v41, s[62:63], 0, v41, s[62:63]
v_cmp_lt_u32 s[56:57], v72, v38
v_cmp_lt_u32 s[58:59], v73, v38
v_cmp_lt_u32 s[60:61], v74, v38
v_cmp_lt_u32 s[62:63], v75, v38
v_addc_co_u32 v40, s[56:57], 0, v40, s[56:57]
v_addc_co_u32 v41, s[58:59], 0, v41, s[58:59]
v_addc_co_u32 v40, s[60:61], 0, v40, s[60:61]
v_addc_co_u32 v41, s[62:63], 0, v41, s[62:63]
v_cmp_lt_u32 s[56:57], v76, v38
v_cmp_lt_u32 s[58:59], v77, v38
v_cmp_lt_u32 s[60:61], v78, v38
v_cmp_lt_u32 s[62:63], v79, v38
v_addc_co_u32 v40, s[56:57], 0, v40, s[56:57]
v_addc_co_u32 v41, s[58:59], 0, v41, s[58:59]
v_addc_co_u32 v40, s[60:61], 0, v40, s[60:61]
v_addc_co_u32 v41, s[62:63], 0, v41, s[62:63]
v_add_u32 v40, v40, v41
s_nop 1
v_add_u32_dpp v40, v40, v40 quad_perm:[1,0,3,2] row_mask:0xf bank_mask:0xf
s_nop 1
v_add_u32_dpp v40, v40, v40 quad_perm:[2,3,0,1] row_mask:0xf bank_mask:0xf
s_nop 1
v_add_u32_dpp v40, v40, v40 row_half_mirror row_mask:0xf bank_mask:0xf
v_lshlrev_b32 v39, 1, v36
s_lshl_b32 s44, s2, 8
s_add_u32 s44, s44, 0x2810000
v_cmp_eq_u32 vcc, 0, v37
s_and_b64 exec, s[42:43], vcc
buffer_store_short v40, v39, s[32:35], s44 offen sc1
s_mov_b64 exec, s[42:43]
s_movk_i32 s48, 0x3e38
s_movk_i32 s49, 0x3e2b
v_mov_b32 v60, 0x40020000
v_mov_b32 v61, 0x40000
s_waitcnt vmcnt(3)
v_cmp_gt_u32 vcc, s48, v56
s_nop 1
v_cndmask_b32 v22, v61, v60, vcc
v_cmp_gt_u32 vcc, s49, v56
s_nop 1
v_cndmask_b32 v22, v22, 0, vcc
v_or_b32 v8, v8, v22
v_cmp_gt_u32 vcc, s48, v57
s_nop 1
v_cndmask_b32 v22, v61, v60, vcc
v_cmp_gt_u32 vcc, s49, v57
s_nop 1
v_cndmask_b32 v22, v22, 0, vcc
v_or_b32 v9, v9, v22
v_cmp_gt_u32 vcc, s48, v58
s_nop 1
v_cndmask_b32 v22, v61, v60, vcc
v_cmp_gt_u32 vcc, s49, v58
s_nop 1
v_cndmask_b32 v22, v22, 0, vcc
v_or_b32 v10, v10, v22
v_cmp_gt_u32 vcc, s48, v59
s_nop 1
v_cndmask_b32 v22, v61, v60, vcc
v_cmp_gt_u32 vcc, s49, v59
s_nop 1
v_cndmask_b32 v22, v22, 0, vcc
v_or_b32 v11, v11, v22
v_cmp_gt_u32 vcc, 63, v32
v_lshl_add_u32 v28, v32, 2, v28
s_and_b64 exec, s[42:43], vcc
ds_write_b32 v28, v8 offset:1028
v_cmp_gt_u32 vcc, 63, v33
v_lshl_add_u32 v29, v33, 2, v29
s_and_b64 exec, s[42:43], vcc
ds_write_b32 v29, v9 offset:1028
v_cmp_gt_u32 vcc, 63, v34
v_lshl_add_u32 v30, v34, 2, v30
s_and_b64 exec, s[42:43], vcc
ds_write_b32 v30, v10 offset:1028
v_cmp_gt_u32 vcc, 63, v35
v_lshl_add_u32 v31, v35, 2, v31
s_and_b64 exec, s[42:43], vcc
ds_write_b32 v31, v11 offset:1028
s_branch K1_B1
K1_SKIP:
s_barrier
K1_B1:
s_mov_b64 exec, -1
s_waitcnt lgkmcnt(0)
s_barrier
s_movk_i32 s14, 1000
v_cmp_gt_u32 vcc, s14, v0
s_and_b64 exec, exec, vcc
s_cbranch_execz K1_END
s_mov_b64 s[42:43], exec
v_lshrrev_b32 v4, 2, v0
v_and_b32 v5, 3, v0
v_lshlrev_b32 v6, 2, v4
ds_read_b32 v7, v6
v_mul_u32_u24 v8, s47, v4
v_lshl_add_u32 v8, v5, 4, v8
ds_read_b128 v[12:15], v8 offset:1024
ds_read_b128 v[16:19], v8 offset:1088
s_movk_i32 s45, 32000
v_mul_u32_u24 v9, s45, v4
v_lshl_add_u32 v9, v5, 4, v9
s_lshl_b32 s44, s2, 7
v_lshlrev_b32 v10, 2, v5
v_cmp_eq_u32 vcc, 0, v5
s_waitcnt lgkmcnt(0)
s_nop 0
v_cndmask_b32 v12, v12, v7, vcc
v_sub_u32 v11, v7, v10
v_cmp_le_i32 vcc, 0, v11
s_and_b64 exec, s[42:43], vcc
buffer_store_dwordx4 v[12:15], v9, s[32:35], s44 offen sc1
v_cmp_le_i32 vcc, 16, v11
s_and_b64 exec, s[42:43], vcc
buffer_store_dwordx4 v[16:19], v9, s[32:35], s44 offen offset:64 sc1
v_cmp_le_i32 vcc, 32, v11
s_and_b64 exec, s[42:43], vcc
s_cbranch_execz K1_NOEXT
ds_read_b128 v[12:15], v8 offset:1152
ds_read_b128 v[16:19], v8 offset:1216
s_lshl_b32 s44, s2, 7
s_add_u32 s44, s44, 0x3000000
s_waitcnt lgkmcnt(0)
buffer_store_dwordx4 v[12:15], v9, s[32:35], s44 offen
buffer_store_dwordx4 v[16:19], v9, s[32:35], s44 offen offset:64
K1_NOEXT:
s_endpgm
K1_W:
s_load_dwordx8 s[16:23], s[0:1], 32
s_load_dwordx2 s[56:57], s[0:1], 64
v_lshrrev_b32 v1, 6, v0
v_and_b32 v2, 63, v0
v_readfirstlane_b32 s3, v1
v_lshrrev_b32 v3, 4, v2
v_and_b32 v4, 15, v2
s_lshr_b32 s24, s3, 2
s_and_b32 s25, s3, 3
v_lshrrev_b32 v5, 2, v4
v_and_b32 v6, 3, v4
v_lshl_add_u32 v7, v5, 4, v6
s_lshl_b32 s26, s25, 2
s_lshl_b32 s27, s24, 2
v_add_u32 v8, s26, v7
v_add_u32 v9, s27, v7
v_lshlrev_b32 v10, 7, v8
v_lshl_add_u32 v10, v3, 4, v10
v_lshlrev_b32 v11, 7, v9
v_lshl_add_u32 v11, v3, 4, v11
s_waitcnt lgkmcnt(0)
s_mov_b32 s28, s16
s_mov_b32 s29, s17
s_mov_b32 s30, 8192
s_mov_b32 s31, 0x00020000
s_mov_b32 s32, s18
s_mov_b32 s33, s19
s_mov_b32 s34, 8192
s_mov_b32 s35, 0x00020000
s_mov_b32 s36, s20
s_mov_b32 s37, s21
s_mov_b32 s38, 8192
s_mov_b32 s39, 0x00020000
s_mov_b32 s40, s22
s_mov_b32 s41, s23
s_mov_b32 s42, 8192
s_mov_b32 s43, 0x00020000
s_add_u32 s44, s12, 0x2800000
s_addc_u32 s45, s13, 0
s_mov_b32 s46, 18448
s_mov_b32 s47, 0x00020000
s_mov_b32 s52, s56
s_mov_b32 s53, s57
s_mov_b32 s54, 128
s_mov_b32 s55, 0x00020000
buffer_load_dwordx4 v[16:19], v10, s[28:31], 0 offen
buffer_load_dwordx4 v[20:23], v10, s[28:31], 0 offen offset:64
buffer_load_dwordx4 v[24:27], v11, s[32:35], 0 offen
buffer_load_dwordx4 v[28:31], v11, s[32:35], 0 offen offset:64
buffer_load_dwordx4 v[32:35], v10, s[36:39], 0 offen
buffer_load_dwordx4 v[36:39], v10, s[36:39], 0 offen offset:64
v_lshlrev_b32 v12, 10, v3
v_lshl_add_u32 v12, v9, 1, v12
s_movk_i32 s48, 0x1000
buffer_load_ushort v60, v12, s[40:43], 0 offen offset:0
buffer_load_ushort v61, v12, s[40:43], 0 offen offset:128
buffer_load_ushort v62, v12, s[40:43], 0 offen offset:256
buffer_load_ushort v63, v12, s[40:43], 0 offen offset:384
buffer_load_ushort v64, v12, s[40:43], 0 offen offset:512
buffer_load_ushort v65, v12, s[40:43], 0 offen offset:640
buffer_load_ushort v66, v12, s[40:43], 0 offen offset:768
buffer_load_ushort v67, v12, s[40:43], 0 offen offset:896
buffer_load_ushort v68, v12, s[40:43], s48 offen offset:0
buffer_load_ushort v69, v12, s[40:43], s48 offen offset:128
buffer_load_ushort v70, v12, s[40:43], s48 offen offset:256
buffer_load_ushort v71, v12, s[40:43], s48 offen offset:384
buffer_load_ushort v72, v12, s[40:43], s48 offen offset:512
buffer_load_ushort v73, v12, s[40:43], s48 offen offset:640
buffer_load_ushort v74, v12, s[40:43], s48 offen offset:768
buffer_load_ushort v75, v12, s[40:43], s48 offen offset:896
v_lshlrev_b32 v76, 5, v3
buffer_load_dwordx4 v[80:83], v76, s[52:55], 0 offen
buffer_load_dwordx4 v[84:87], v76, s[52:55], 0 offen offset:16
v_mov_b32 v48, 0
v_mov_b32 v49, 0
v_mov_b32 v50, 0
v_mov_b32 v51, 0
v_mov_b32 v52, 0
v_mov_b32 v53, 0
v_mov_b32 v54, 0
v_mov_b32 v55, 0
s_waitcnt vmcnt(0)
v_lshl_or_b32 v40, v61, 16, v60
v_lshl_or_b32 v41, v63, 16, v62
v_lshl_or_b32 v42, v65, 16, v64
v_lshl_or_b32 v43, v67, 16, v66
v_lshl_or_b32 v44, v69, 16, v68
v_lshl_or_b32 v45, v71, 16, v70
v_lshl_or_b32 v46, v73, 16, v72
v_lshl_or_b32 v47, v75, 16, v74
v_mfma_f32_16x16x32_bf16 v[48:51], v[16:19], v[24:27], v[48:51]
v_mfma_f32_16x16x32_bf16 v[52:55], v[32:35], v[40:43], v[52:55]
v_mfma_f32_16x16x32_bf16 v[48:51], v[20:23], v[28:31], v[48:51]
v_mfma_f32_16x16x32_bf16 v[52:55], v[36:39], v[44:47], v[52:55]
s_cmp_lg_u32 s3, 0
s_cbranch_scc1 K1_W2
v_cmp_eq_u32 s[62:63], 0, v6
v_cmp_eq_u32 s[60:61], 1, v6
v_mov_b32 v77, 0x3f803f80
v_cndmask_b32 v88, 0, v77, s[62:63]
v_cndmask_b32 v88, v88, v80, s[60:61]
v_cndmask_b32 v89, 0, v77, s[62:63]
v_cndmask_b32 v89, v89, v81, s[60:61]
v_cndmask_b32 v90, 0, v77, s[62:63]
v_cndmask_b32 v90, v90, v82, s[60:61]
v_cndmask_b32 v91, 0, v77, s[62:63]
v_cndmask_b32 v91, v91, v83, s[60:61]
v_cndmask_b32 v92, 0, v77, s[62:63]
v_cndmask_b32 v92, v92, v84, s[60:61]
v_cndmask_b32 v93, 0, v77, s[62:63]
v_cndmask_b32 v93, v93, v85, s[60:61]
v_cndmask_b32 v94, 0, v77, s[62:63]
v_cndmask_b32 v94, v94, v86, s[60:61]
v_cndmask_b32 v95, 0, v77, s[62:63]
v_cndmask_b32 v95, v95, v87, s[60:61]
v_mov_b32 v80, 0x3f803f80
v_mov_b32 v81, 0x3f803f80
v_mov_b32 v82, 0x3f803f80
v_mov_b32 v83, 0x3f803f80
s_nop 1
v_mfma_f32_16x16x32_bf16 v[84:87], v[88:91], v[80:83], 0
v_mfma_f32_16x16x32_bf16 v[84:87], v[92:95], v[80:83], v[84:87]
v_lshlrev_b32 v13, 4, v2
s_movk_i32 s50, 0x4000
buffer_store_dwordx4 v[88:91], v13, s[44:47], s50 offen
buffer_store_dwordx4 v[92:95], v13, s[44:47], s50 offen offset:1024
s_nop 3
v_mov_b32 v84, v85
v_mov_b32 v86, v85
v_mov_b32 v87, v85
v_mov_b32 v13, 0
s_movk_i32 s50, 0x4800
s_mov_b64 exec, 1
buffer_store_dwordx4 v[84:87], v13, s[44:47], s50 offen
s_mov_b64 exec, -1
K1_W2:
s_nop 4
v_add_f32 v56, v48, v49
v_add_f32 v57, v50, v51
v_add_f32 v56, v56, v57
v_add_f32 v58, v52, v53
v_add_f32 v59, v54, v55
v_add_f32 v58, v58, v59
v_mov_b32 v57, v56
s_nop 1
v_permlane16_swap_b32 v56, v57
v_add_f32 v56, v56, v57
v_mov_b32 v57, v56
s_nop 1
v_permlane32_swap_b32 v56, v57
v_add_f32 v56, v56, v57
v_mov_b32 v59, v58
s_nop 1
v_permlane16_swap_b32 v58, v59
v_add_f32 v58, v58, v59
v_mov_b32 v59, v58
s_nop 1
v_permlane32_swap_b32 v58, v59
v_add_f32 v58, v58, v59
v_mov_b32 v60, v56
s_nop 1
v_add_f32_dpp v60, v60, v60 row_ror:8 row_mask:0xf bank_mask:0xf
s_nop 1
v_add_f32_dpp v60, v60, v60 row_ror:4 row_mask:0xf bank_mask:0xf
s_nop 1
v_add_f32_dpp v60, v60, v60 row_ror:2 row_mask:0xf bank_mask:0xf
s_nop 1
v_add_f32_dpp v60, v60, v60 row_ror:1 row_mask:0xf bank_mask:0xf
v_mov_b32 v62, v48
s_nop 1
v_add_f32_dpp v62, v62, v62 row_ror:8 row_mask:0xf bank_mask:0xf
s_nop 1
v_add_f32_dpp v62, v62, v62 row_ror:4 row_mask:0xf bank_mask:0xf
s_nop 1
v_add_f32_dpp v62, v62, v62 row_ror:2 row_mask:0xf bank_mask:0xf
s_nop 1
v_add_f32_dpp v62, v62, v62 row_ror:1 row_mask:0xf bank_mask:0xf
v_mov_b32 v63, v49
s_nop 1
v_add_f32_dpp v63, v63, v63 row_ror:8 row_mask:0xf bank_mask:0xf
s_nop 1
v_add_f32_dpp v63, v63, v63 row_ror:4 row_mask:0xf bank_mask:0xf
s_nop 1
v_add_f32_dpp v63, v63, v63 row_ror:2 row_mask:0xf bank_mask:0xf
s_nop 1
v_add_f32_dpp v63, v63, v63 row_ror:1 row_mask:0xf bank_mask:0xf
v_mov_b32 v64, v50
s_nop 1
v_add_f32_dpp v64, v64, v64 row_ror:8 row_mask:0xf bank_mask:0xf
s_nop 1
v_add_f32_dpp v64, v64, v64 row_ror:4 row_mask:0xf bank_mask:0xf
s_nop 1
v_add_f32_dpp v64, v64, v64 row_ror:2 row_mask:0xf bank_mask:0xf
s_nop 1
v_add_f32_dpp v64, v64, v64 row_ror:1 row_mask:0xf bank_mask:0xf
v_mov_b32 v65, v51
s_nop 1
v_add_f32_dpp v65, v65, v65 row_ror:8 row_mask:0xf bank_mask:0xf
s_nop 1
v_add_f32_dpp v65, v65, v65 row_ror:4 row_mask:0xf bank_mask:0xf
s_nop 1
v_add_f32_dpp v65, v65, v65 row_ror:2 row_mask:0xf bank_mask:0xf
s_nop 1
v_add_f32_dpp v65, v65, v65 row_ror:1 row_mask:0xf bank_mask:0xf
v_lshlrev_b32 v14, 4, v9
s_lshl_b32 s50, s25, 2
v_add_u32 v14, s50, v14
ds_write_b32 v14, v56
ds_write_b32 v14, v58 offset:1024
v_lshlrev_b32 v15, 8, v3
s_lshl_b32 s50, s25, 6
s_lshl_b32 s51, s24, 2
s_add_u32 s50, s50, s51
v_add_u32 v15, s50, v15
ds_write_b32 v15, v62 offset:2048
ds_write_b32 v15, v63 offset:2064
ds_write_b32 v15, v64 offset:2080
ds_write_b32 v15, v65 offset:2096
s_lshl_b32 s50, s3, 2
v_mov_b32 v61, s50
ds_write_b32 v61, v60 offset:3072
s_waitcnt lgkmcnt(0)
s_barrier
v_lshlrev_b32 v14, 4, v9
ds_read_b128 v[16:19], v14
ds_read_b128 v[20:23], v14 offset:1024
v_lshlrev_b32 v15, 8, v3
s_lshl_b32 s50, s25, 6
v_add_u32 v15, s50, v15
ds_read_b128 v[24:27], v15 offset:2048
ds_read_b128 v[28:31], v15 offset:2064
ds_read_b128 v[32:35], v15 offset:2080
ds_read_b128 v[36:39], v15 offset:2096
v_mov_b32 v61, 3072
ds_read_b128 v[64:67], v61 offset:0
ds_read_b128 v[68:71], v61 offset:16
ds_read_b128 v[72:75], v61 offset:32
ds_read_b128 v[76:79], v61 offset:48
s_waitcnt lgkmcnt(0)
v_add_f32 v16, v16, v17
v_add_f32 v18, v18, v19
v_add_f32 v16, v16, v18
v_add_f32 v20, v20, v21
v_add_f32 v22, v22, v23
v_add_f32 v20, v20, v22
v_add_f32 v24, v24, v25
v_add_f32 v26, v26, v27
v_add_f32 v24, v24, v26
v_add_f32 v28, v28, v29
v_add_f32 v30, v30, v31
v_add_f32 v28, v28, v30
v_add_f32 v32, v32, v33
v_add_f32 v34, v34, v35
v_add_f32 v32, v32, v34
v_add_f32 v36, v36, v37
v_add_f32 v38, v38, v39
v_add_f32 v36, v36, v38
v_add_f32 v64, v64, v65
v_add_f32 v66, v66, v67
v_add_f32 v64, v64, v66
v_add_f32 v68, v68, v69
v_add_f32 v70, v70, v71
v_add_f32 v68, v68, v70
v_add_f32 v72, v72, v73
v_add_f32 v74, v74, v75
v_add_f32 v72, v72, v74
v_add_f32 v76, v76, v77
v_add_f32 v78, v78, v79
v_add_f32 v76, v76, v78
v_add_f32 v64, v64, v68
v_add_f32 v72, v72, v76
v_add_f32 v64, v64, v72
s_mov_b32 s48, 0x3c800000
v_mul_f32 v64, s48, v64
v_sub_f32 v16, v16, v64
s_mov_b32 s49, 0x3e38aa3b
v_add_f32 v17, v16, v24
v_fma_f32 v48, -v17, s48, v48
v_mul_f32 v48, s49, v48
v_fma_f32 v52, -v20, s48, v52
v_add_f32 v17, v16, v28
v_fma_f32 v49, -v17, s48, v49
v_mul_f32 v49, s49, v49
v_fma_f32 v53, -v20, s48, v53
v_add_f32 v17, v16, v32
v_fma_f32 v50, -v17, s48, v50
v_mul_f32 v50, s49, v50
v_fma_f32 v54, -v20, s48, v54
v_add_f32 v17, v16, v36
v_fma_f32 v51, -v17, s48, v51
v_mul_f32 v51, s49, v51
v_fma_f32 v55, -v20, s48, v55
v_cvt_pk_bf16_f32 v56, v48, v49
v_cvt_pk_bf16_f32 v57, v50, v51
v_cvt_pk_bf16_f32 v58, v52, v53
v_cvt_pk_bf16_f32 v59, v54, v55
s_lshl_b32 s50, s24, 11
s_lshr_b32 s51, s25, 1
s_lshl_b32 s51, s51, 10
s_add_u32 s50, s50, s51
s_and_b32 s51, s25, 1
s_lshl_b32 s51, s51, 3
s_add_u32 s50, s50, s51
v_lshlrev_b32 v13, 4, v2
buffer_store_dwordx2 v[56:57], v13, s[44:47], s50 offen
s_add_u32 s50, s50, 8192
buffer_store_dwordx2 v[58:59], v13, s[44:47], s50 offen
K1_END:
s_endpgm
.globl graph_kernel
.p2align 8
.type graph_kernel,@function
graph_kernel:
s_cmp_ge_u32 s2, 250
s_cbranch_scc1 P_END
s_load_dwordx8 s[4:11], s[0:1], 0
s_load_dwordx2 s[12:13], s[0:1], 88
s_load_dwordx2 s[14:15], s[0:1], 72
v_and_b32 v1, 63, v0
v_lshrrev_b32 v40, 6, v0
v_lshlrev_b32 v45, 4, v0
v_readfirstlane_b32 s3, v40
s_movk_i32 s74, 128
s_mov_b32 s99, 0x3f803f80
s_mul_i32 s62, s2, 32000
s_add_u32 s63, s62, 16000
v_lshrrev_b32 v112, 3, v0
v_and_b32 v113, 7, v0
v_lshlrev_b32 v54, 1, v112
s_waitcnt lgkmcnt(0)
s_mov_b32 s20, s12
s_mov_b32 s21, s13
s_mov_b32 s22, 0x8000000
s_mov_b32 s23, 0x00020000
buffer_load_dwordx4 v[64:67], v45, s[20:23], s62 offen
buffer_load_dwordx4 v[68:71], v45, s[20:23], s63 offen
s_mov_b32 s32, s4
s_mov_b32 s33, s5
s_mov_b32 s34, 3200000
s_mov_b32 s35, 0x00020000
s_mov_b32 s36, s10
s_mov_b32 s37, s11
s_mov_b32 s38, 50000
s_mov_b32 s39, 0x00020000
s_mul_i32 s63, s2, 12800
buffer_load_dwordx4 v[32:35], v45, s[32:35], s63 offen
s_mul_i32 s64, s2, 200
buffer_load_ushort v55, v54, s[36:39], s64 offen
s_lshl_b32 s64, s2, 8
s_add_u32 s64, s64, 0x2810000
buffer_load_ushort v121, v54, s[20:23], s64 offen
s_mov_b32 s44, s14
s_mov_b32 s45, s15
s_mov_b32 s46, 3200000
s_mov_b32 s47, 0x00020000
s_lshr_b32 s54, s2, 3
s_mul_i32 s54, s54, 103424
v_lshl_add_u32 v12, v0, 7, s54
s_mov_b32 s55, 3200000
v_cmp_gt_u32 vcc, s55, v12
s_movk_i32 s55, 808
v_cmp_gt_u32 s[62:63], s55, v0
s_and_b64 vcc, vcc, s[62:63]
v_bfrev_b32 v13, 1
v_cndmask_b32 v12, v13, v12, vcc
s_movk_i32 s55, 0
v_cmp_le_u32 vcc, s55, v0
s_movk_i32 s55, 320
v_cmp_gt_u32 s[62:63], s55, v0
s_and_b64 vcc, vcc, s[62:63]
v_cndmask_b32 v14, v13, v12, vcc
s_movk_i32 s55, 320
v_cmp_le_u32 vcc, s55, v0
s_movk_i32 s55, 640
v_cmp_gt_u32 s[62:63], s55, v0
s_and_b64 vcc, vcc, s[62:63]
v_cndmask_b32 v15, v13, v12, vcc
s_movk_i32 s55, 640
v_cmp_le_u32 vcc, s55, v0
s_movk_i32 s55, 960
v_cmp_gt_u32 s[62:63], s55, v0
s_and_b64 vcc, vcc, s[62:63]
v_cndmask_b32 v16, v13, v12, vcc
s_mov_b32 s55, 0x800000
v_mov_b32 v48, -1
v_mov_b32 v49, -1
v_mov_b32 v50, -1
v_mov_b32 v51, -1
v_mov_b32 v116, 0
v_mov_b32 v117, 0
v_mov_b32 v118, 0
v_mov_b32 v119, 0
ds_write_b128 v45, v[48:51]
v_cmp_gt_u32 vcc, 20, v0
s_and_saveexec_b64 s[64:65], vcc
ds_write_b128 v45, v[48:51] offset:16384
s_mov_b64 exec, s[64:65]
s_movk_i32 s62, 200
v_cmp_gt_u32 vcc, s62, v0
s_and_saveexec_b64 s[64:65], vcc
ds_write_b128 v45, v[116:119] offset:16704
s_mov_b64 exec, s[64:65]
s_movk_i32 s62, 800
v_cmp_gt_u32 vcc, s62, v0
s_mov_b64 s[60:61], vcc
v_and_b32 v96, 7, v1
v_lshlrev_b32 v2, 4, v96
v_lshrrev_b32 v97, 1, v96
v_and_b32 v98, 1, v96
v_lshlrev_b32 v98, 4, v98
v_mov_b32 v99, 0x3f80
v_lshlrev_b32 v99, v98, v99
v_lshrrev_b32 v100, 4, v1
v_bfe_u32 v101, v1, 3, 1
v_add_u32 v102, 2, v101
v_cmp_eq_u32 s[62:63], v100, v101
v_cmp_eq_u32 s[64:65], v100, v102
v_cmp_eq_u32 vcc, 0, v97
s_and_b64 s[68:69], vcc, s[62:63]
v_cndmask_b32 v4, 0, v99, s[68:69]
s_and_b64 s[68:69], vcc, s[64:65]
v_cndmask_b32 v8, 0, v99, s[68:69]
v_cmp_eq_u32 vcc, 1, v97
s_and_b64 s[68:69], vcc, s[62:63]
v_cndmask_b32 v5, 0, v99, s[68:69]
s_and_b64 s[68:69], vcc, s[64:65]
v_cndmask_b32 v9, 0, v99, s[68:69]
v_cmp_eq_u32 vcc, 2, v97
s_and_b64 s[68:69], vcc, s[62:63]
v_cndmask_b32 v6, 0, v99, s[68:69]
s_and_b64 s[68:69], vcc, s[64:65]
v_cndmask_b32 v10, 0, v99, s[68:69]
v_cmp_eq_u32 vcc, 3, v97
s_and_b64 s[68:69], vcc, s[62:63]
v_cndmask_b32 v7, 0, v99, s[68:69]
s_and_b64 s[68:69], vcc, s[64:65]
v_cndmask_b32 v11, 0, v99, s[68:69]
v_lshrrev_b32 v103, 1, v100
v_lshl_add_u32 v126, v103, 1, v101
v_and_b32 v103, 1, v100
v_lshl_add_u32 v127, v103, 2, v126
v_mov_b32 v22, 19856
v_lshlrev_b32 v47, 2, v113
s_movk_i32 s62, 1000
v_cmp_gt_u32 s[66:67], s62, v0
v_cmp_eq_u32 s[68:69], 0, v113
v_mov_b32 v114, 2
v_mov_b32 v116, 0x3fc
s_waitcnt lgkmcnt(0)
s_barrier
s_waitcnt vmcnt(3)
buffer_load_dword v23, v14, s[20:23], s55 offen
v_mov_b32_dpp v56, v64 quad_perm:[0,0,0,0] row_mask:0xf bank_mask:0xf
s_nop 1
v_mov_b32_dpp v56, v56 row_shr:4 row_mask:0xf bank_mask:0xa
v_cndmask_b32 v56, 0, v56, s[66:67]
v_min_u32 v58, 31, v56
v_sub_u32 v48, v58, v47
v_add_u32 v48, 1, v48
v_cndmask_b32 v49, v48, 0, s[68:69]
v_min_u32 v58, 63, v56
v_sub_u32 v52, v58, v47
v_subrev_u32 v52, 31, v52
v_mov_b32_dpp v57, v68 quad_perm:[0,0,0,0] row_mask:0xf bank_mask:0xf
s_nop 1
v_mov_b32_dpp v57, v57 row_shr:4 row_mask:0xf bank_mask:0xa
v_cndmask_b32 v57, 0, v57, s[66:67]
v_min_u32 v58, 31, v57
v_sub_u32 v50, v58, v47
v_add_u32 v50, 1, v50
v_cndmask_b32 v51, v50, 0, s[68:69]
v_min_u32 v58, 63, v57
v_sub_u32 v53, v58, v47
v_subrev_u32 v53, 31, v53
v_max_u32 v58, v56, v57
v_cmp_lt_u32 vcc, 31, v58
s_mov_b32 s72, 0
s_cbranch_vccz P_NOEXT
s_mov_b32 s72, 1
s_mul_i32 s62, s2, 32000
s_add_u32 s62, s62, 0x3000000
s_add_u32 s63, s62, 16000
buffer_load_dwordx4 v[72:75], v45, s[20:23], s62 offen
buffer_load_dwordx4 v[76:79], v45, s[20:23], s63 offen
v_cmp_lt_u32 vcc, 63, v58
s_and_saveexec_b64 s[64:65], vcc
v_mov_b32 v59, 1
v_mov_b32 v58, 19840
ds_write_b32 v58, v59
s_mov_b64 exec, s[64:65]
s_waitcnt vmcnt(0)
P_NOEXT:
v_cmpx_lt_i32 vcc, 1, v48
v_and_b32_sdwa v20, v65, v116 dst_sel:DWORD dst_unused:UNUSED_PAD src0_sel:WORD_1 src1_sel:DWORD
v_lshrrev_b32 v21, 26, v65
v_lshlrev_b32 v21, v21, v114
ds_add_rtn_u32 v81, v20, v21 offset:16704
v_cmpx_lt_i32 vcc, 2, v48
v_and_b32_sdwa v20, v66, v116 dst_sel:DWORD dst_unused:UNUSED_PAD src0_sel:WORD_1 src1_sel:DWORD
v_lshrrev_b32 v21, 26, v66
v_lshlrev_b32 v21, v21, v114
ds_add_rtn_u32 v82, v20, v21 offset:16704
v_cmpx_lt_i32 vcc, 3, v48
v_and_b32_sdwa v20, v67, v116 dst_sel:DWORD dst_unused:UNUSED_PAD src0_sel:WORD_1 src1_sel:DWORD
v_lshrrev_b32 v21, 26, v67
v_lshlrev_b32 v21, v21, v114
ds_add_rtn_u32 v83, v20, v21 offset:16704
s_mov_b64 exec, -1
v_cmpx_lt_i32 vcc, 0, v49
v_and_b32_sdwa v20, v64, v116 dst_sel:DWORD dst_unused:UNUSED_PAD src0_sel:WORD_1 src1_sel:DWORD
v_lshrrev_b32 v21, 26, v64
v_lshlrev_b32 v21, v21, v114
ds_add_rtn_u32 v80, v20, v21 offset:16704
s_mov_b64 exec, -1
v_cmpx_lt_i32 vcc, 1, v50
v_and_b32_sdwa v20, v69, v116 dst_sel:DWORD dst_unused:UNUSED_PAD src0_sel:WORD_1 src1_sel:DWORD
v_lshrrev_b32 v21, 26, v69
v_lshlrev_b32 v21, v21, v114
ds_add_rtn_u32 v85, v20, v21 offset:16704
v_cmpx_lt_i32 vcc, 2, v50
v_and_b32_sdwa v20, v70, v116 dst_sel:DWORD dst_unused:UNUSED_PAD src0_sel:WORD_1 src1_sel:DWORD
v_lshrrev_b32 v21, 26, v70
v_lshlrev_b32 v21, v21, v114
ds_add_rtn_u32 v86, v20, v21 offset:16704
v_cmpx_lt_i32 vcc, 3, v50
v_and_b32_sdwa v20, v71, v116 dst_sel:DWORD dst_unused:UNUSED_PAD src0_sel:WORD_1 src1_sel:DWORD
v_lshrrev_b32 v21, 26, v71
v_lshlrev_b32 v21, v21, v114
ds_add_rtn_u32 v87, v20, v21 offset:16704
s_mov_b64 exec, -1
v_cmpx_lt_i32 vcc, 0, v51
v_and_b32_sdwa v20, v68, v116 dst_sel:DWORD dst_unused:UNUSED_PAD src0_sel:WORD_1 src1_sel:DWORD
v_lshrrev_b32 v21, 26, v68
v_lshlrev_b32 v21, v21, v114
ds_add_rtn_u32 v84, v20, v21 offset:16704
s_mov_b64 exec, -1
s_cmp_eq_u32 s72, 0
s_cbranch_scc1 P_AT_D
v_cmpx_lt_i32 vcc, 0, v52
v_and_b32_sdwa v20, v72, v116 dst_sel:DWORD dst_unused:UNUSED_PAD src0_sel:WORD_1 src1_sel:DWORD
v_lshrrev_b32 v21, 26, v72
v_lshlrev_b32 v21, v21, v114
ds_add_rtn_u32 v88, v20, v21 offset:16704
v_cmpx_lt_i32 vcc, 1, v52
v_and_b32_sdwa v20, v73, v116 dst_sel:DWORD dst_unused:UNUSED_PAD src0_sel:WORD_1 src1_sel:DWORD
v_lshrrev_b32 v21, 26, v73
v_lshlrev_b32 v21, v21, v114
ds_add_rtn_u32 v89, v20, v21 offset:16704
v_cmpx_lt_i32 vcc, 2, v52
v_and_b32_sdwa v20, v74, v116 dst_sel:DWORD dst_unused:UNUSED_PAD src0_sel:WORD_1 src1_sel:DWORD
v_lshrrev_b32 v21, 26, v74
v_lshlrev_b32 v21, v21, v114
ds_add_rtn_u32 v90, v20, v21 offset:16704
v_cmpx_lt_i32 vcc, 3, v52
v_and_b32_sdwa v20, v75, v116 dst_sel:DWORD dst_unused:UNUSED_PAD src0_sel:WORD_1 src1_sel:DWORD
v_lshrrev_b32 v21, 26, v75
v_lshlrev_b32 v21, v21, v114
ds_add_rtn_u32 v91, v20, v21 offset:16704
s_mov_b64 exec, -1
v_cmpx_lt_i32 vcc, 0, v53
v_and_b32_sdwa v20, v76, v116 dst_sel:DWORD dst_unused:UNUSED_PAD src0_sel:WORD_1 src1_sel:DWORD
v_lshrrev_b32 v21, 26, v76
v_lshlrev_b32 v21, v21, v114
ds_add_rtn_u32 v92, v20, v21 offset:16704
v_cmpx_lt_i32 vcc, 1, v53
v_and_b32_sdwa v20, v77, v116 dst_sel:DWORD dst_unused:UNUSED_PAD src0_sel:WORD_1 src1_sel:DWORD
v_lshrrev_b32 v21, 26, v77
v_lshlrev_b32 v21, v21, v114
ds_add_rtn_u32 v93, v20, v21 offset:16704
v_cmpx_lt_i32 vcc, 2, v53
v_and_b32_sdwa v20, v78, v116 dst_sel:DWORD dst_unused:UNUSED_PAD src0_sel:WORD_1 src1_sel:DWORD
v_lshrrev_b32 v21, 26, v78
v_lshlrev_b32 v21, v21, v114
ds_add_rtn_u32 v94, v20, v21 offset:16704
v_cmpx_lt_i32 vcc, 3, v53
v_and_b32_sdwa v20, v79, v116 dst_sel:DWORD dst_unused:UNUSED_PAD src0_sel:WORD_1 src1_sel:DWORD
v_lshrrev_b32 v21, 26, v79
v_lshlrev_b32 v21, v21, v114
ds_add_rtn_u32 v95, v20, v21 offset:16704
s_mov_b64 exec, -1
P_AT_D:
s_waitcnt vmcnt(1)
buffer_load_dword v23, v15, s[20:23], s55 offen
v_lshlrev_b32 v118, 3, v112
v_lshlrev_b32 v55, 16, v55
v_dot2_f32_bf16 v36, v32, v32, 0
v_dot2_f32_bf16 v37, v32, s99, 0
v_dot2_f32_bf16 v36, v33, v33, v36
v_dot2_f32_bf16 v37, v33, s99, v37
v_dot2_f32_bf16 v36, v34, v34, v36
v_dot2_f32_bf16 v37, v34, s99, v37
v_dot2_f32_bf16 v36, v35, v35, v36
v_dot2_f32_bf16 v37, v35, s99, v37
s_nop 1
v_add_f32_dpp v36, v36, v36 quad_perm:[1,0,3,2] row_mask:0xf bank_mask:0xf
v_add_f32_dpp v37, v37, v37 quad_perm:[1,0,3,2] row_mask:0xf bank_mask:0xf
s_nop 0
v_add_f32_dpp v36, v36, v36 quad_perm:[2,3,0,1] row_mask:0xf bank_mask:0xf
v_add_f32_dpp v37, v37, v37 quad_perm:[2,3,0,1] row_mask:0xf bank_mask:0xf
s_nop 0
v_add_f32_dpp v36, v36, v36 row_half_mirror row_mask:0xf bank_mask:0xf
v_add_f32_dpp v37, v37, v37 row_half_mirror row_mask:0xf bank_mask:0xf
v_mul_f32 v37, 0x3c800000, v37
v_mul_f32 v38, v37, v37
v_mul_f32 v36, 0x3c800000, v36
v_sub_f32 v36, v36, v38
v_max_f32 v36, 0, v36
v_add_f32 v36, 0x3727c5ac, v36
v_rsq_f32 v36, v36
s_movk_i32 s66, 1152
v_mul_u32_u24 v37, s66, v121
v_lshl_add_u32 v37, v113, 4, v37
v_lshlrev_b32 v38, 5, v121
s_movk_i32 s66, 160
v_mov_b32 v62, 158
v_mad_u32_u24 v62, v121, s66, v62
v_lshlrev_b32 v63, 2, v121
v_lshrrev_b32 v59, 3, v121
v_lshlrev_b32 v59, 2, v59
s_mov_b64 exec, s[60:61]
ds_write_b128 v37, v[32:35] offset:44752
v_cmp_eq_u32 vcc, 0, v113
s_and_b64 s[68:69], exec, vcc
s_mov_b64 exec, s[68:69]
ds_write_b32 v38, v36 offset:41424
ds_write_b32 v63, v112 offset:18752
ds_write_b32 v63, v55 offset:19328
s_mov_b64 exec, -1
s_waitcnt lgkmcnt(0)
s_barrier
s_mov_b64 exec, s[68:69]
s_cbranch_execz P_RK_D
ds_read_b64 v[56:57], v118 offset:16704
s_mov_b32 s66, 0x10001
s_movk_i32 s67, 160
s_waitcnt lgkmcnt(0)
v_sub_u32 v46, v62, v57
v_lshrrev_b32 v47, 16, v56
v_sub_u32 v47, v46, v47
v_and_b32 v47, 0xffff, v47
v_lshl_or_b32 v46, v46, 16, v47
v_mov_b32 v47, v62
ds_write_b64 v118, v[46:47] offset:17728
v_dot2_u32_u16 v58, v56, s66, v57
s_nop 2
ds_max_u32 v59, v58 offset:19264
v_cmp_lt_u32 vcc, s67, v58
s_and_b64 exec, exec, vcc
v_mov_b32 v63, 1
v_mov_b32 v62, 19840
ds_write_b32 v62, v63
P_RK_D:
s_mov_b64 exec, -1
v_mov_b32 v60, 19840
s_waitcnt lgkmcnt(0)
s_barrier
buffer_load_dword v23, v16, s[20:23], s55 offen
ds_read_b32 v61, v60
v_mov_b32 v116, 0x3fe
v_and_b32_sdwa v115, v64, v116 dst_sel:DWORD dst_unused:UNUSED_PAD src0_sel:WORD_1 src1_sel:DWORD
ds_read_u16 v96, v115 offset:17728
v_and_b32_sdwa v115, v65, v116 dst_sel:DWORD dst_unused:UNUSED_PAD src0_sel:WORD_1 src1_sel:DWORD
ds_read_u16 v97, v115 offset:17728
v_and_b32_sdwa v115, v66, v116 dst_sel:DWORD dst_unused:UNUSED_PAD src0_sel:WORD_1 src1_sel:DWORD
ds_read_u16 v98, v115 offset:17728
v_and_b32_sdwa v115, v67, v116 dst_sel:DWORD dst_unused:UNUSED_PAD src0_sel:WORD_1 src1_sel:DWORD
ds_read_u16 v99, v115 offset:17728
v_and_b32_sdwa v115, v68, v116 dst_sel:DWORD dst_unused:UNUSED_PAD src0_sel:WORD_1 src1_sel:DWORD
ds_read_u16 v100, v115 offset:17728
v_and_b32_sdwa v115, v69, v116 dst_sel:DWORD dst_unused:UNUSED_PAD src0_sel:WORD_1 src1_sel:DWORD
ds_read_u16 v101, v115 offset:17728
v_and_b32_sdwa v115, v70, v116 dst_sel:DWORD dst_unused:UNUSED_PAD src0_sel:WORD_1 src1_sel:DWORD
ds_read_u16 v102, v115 offset:17728
v_and_b32_sdwa v115, v71, v116 dst_sel:DWORD dst_unused:UNUSED_PAD src0_sel:WORD_1 src1_sel:DWORD
ds_read_u16 v103, v115 offset:17728
s_waitcnt lgkmcnt(8)
v_readfirstlane_b32 s75, v61
s_cmp_lg_u32 s75, 0
s_cbranch_scc1 P_PL_D
s_waitcnt lgkmcnt(4)
v_lshrrev_b32 v115, 26, v64
v_bfe_u32 v80, v80, v115, 16
v_sub_u32 v80, v96, v80
v_lshrrev_b32 v115, 26, v65
v_bfe_u32 v81, v81, v115, 16
v_sub_u32 v81, v97, v81
v_lshrrev_b32 v115, 26, v66
v_bfe_u32 v82, v82, v115, 16
v_sub_u32 v82, v98, v82
v_lshrrev_b32 v115, 26, v67
v_bfe_u32 v83, v83, v115, 16
v_sub_u32 v83, v99, v83
v_cmpx_lt_i32 vcc, 1, v48
ds_write_b16 v81, v65
v_cmpx_lt_i32 vcc, 2, v48
ds_write_b16 v82, v66
v_cmpx_lt_i32 vcc, 3, v48
ds_write_b16 v83, v67
s_mov_b64 exec, -1
v_cmpx_lt_i32 vcc, 0, v49
ds_write_b16 v80, v64
s_mov_b64 exec, -1
s_waitcnt lgkmcnt(4)
v_lshrrev_b32 v115, 26, v68
v_bfe_u32 v84, v84, v115, 16
v_sub_u32 v84, v100, v84
v_lshrrev_b32 v115, 26, v69
v_bfe_u32 v85, v85, v115, 16
v_sub_u32 v85, v101, v85
v_lshrrev_b32 v115, 26, v70
v_bfe_u32 v86, v86, v115, 16
v_sub_u32 v86, v102, v86
v_lshrrev_b32 v115, 26, v71
v_bfe_u32 v87, v87, v115, 16
v_sub_u32 v87, v103, v87
v_cmpx_lt_i32 vcc, 1, v50
ds_write_b16 v85, v69
v_cmpx_lt_i32 vcc, 2, v50
ds_write_b16 v86, v70
v_cmpx_lt_i32 vcc, 3, v50
ds_write_b16 v87, v71
s_mov_b64 exec, -1
v_cmpx_lt_i32 vcc, 0, v51
ds_write_b16 v84, v68
s_mov_b64 exec, -1
s_cmp_eq_u32 s72, 0
s_cbranch_scc1 P_PL_D
v_and_b32_sdwa v115, v72, v116 dst_sel:DWORD dst_unused:UNUSED_PAD src0_sel:WORD_1 src1_sel:DWORD
ds_read_u16 v104, v115 offset:17728
v_and_b32_sdwa v115, v73, v116 dst_sel:DWORD dst_unused:UNUSED_PAD src0_sel:WORD_1 src1_sel:DWORD
ds_read_u16 v105, v115 offset:17728
v_and_b32_sdwa v115, v74, v116 dst_sel:DWORD dst_unused:UNUSED_PAD src0_sel:WORD_1 src1_sel:DWORD
ds_read_u16 v106, v115 offset:17728
v_and_b32_sdwa v115, v75, v116 dst_sel:DWORD dst_unused:UNUSED_PAD src0_sel:WORD_1 src1_sel:DWORD
ds_read_u16 v107, v115 offset:17728
v_and_b32_sdwa v115, v76, v116 dst_sel:DWORD dst_unused:UNUSED_PAD src0_sel:WORD_1 src1_sel:DWORD
ds_read_u16 v108, v115 offset:17728
v_and_b32_sdwa v115, v77, v116 dst_sel:DWORD dst_unused:UNUSED_PAD src0_sel:WORD_1 src1_sel:DWORD
ds_read_u16 v109, v115 offset:17728
v_and_b32_sdwa v115, v78, v116 dst_sel:DWORD dst_unused:UNUSED_PAD src0_sel:WORD_1 src1_sel:DWORD
ds_read_u16 v110, v115 offset:17728
v_and_b32_sdwa v115, v79, v116 dst_sel:DWORD dst_unused:UNUSED_PAD src0_sel:WORD_1 src1_sel:DWORD
ds_read_u16 v111, v115 offset:17728
s_waitcnt lgkmcnt(0)
v_lshrrev_b32 v115, 26, v72
v_bfe_u32 v88, v88, v115, 16
v_sub_u32 v88, v104, v88
v_lshrrev_b32 v115, 26, v73
v_bfe_u32 v89, v89, v115, 16
v_sub_u32 v89, v105, v89
v_lshrrev_b32 v115, 26, v74
v_bfe_u32 v90, v90, v115, 16
v_sub_u32 v90, v106, v90
v_lshrrev_b32 v115, 26, v75
v_bfe_u32 v91, v91, v115, 16
v_sub_u32 v91, v107, v91
v_cmpx_lt_i32 vcc, 0, v52
ds_write_b16 v88, v72
v_cmpx_lt_i32 vcc, 1, v52
ds_write_b16 v89, v73
v_cmpx_lt_i32 vcc, 2, v52
ds_write_b16 v90, v74
v_cmpx_lt_i32 vcc, 3, v52
ds_write_b16 v91, v75
s_mov_b64 exec, -1
v_lshrrev_b32 v115, 26, v76
v_bfe_u32 v92, v92, v115, 16
v_sub_u32 v92, v108, v92
v_lshrrev_b32 v115, 26, v77
v_bfe_u32 v93, v93, v115, 16
v_sub_u32 v93, v109, v93
v_lshrrev_b32 v115, 26, v78
v_bfe_u32 v94, v94, v115, 16
v_sub_u32 v94, v110, v94
v_lshrrev_b32 v115, 26, v79
v_bfe_u32 v95, v95, v115, 16
v_sub_u32 v95, v111, v95
v_cmpx_lt_i32 vcc, 0, v53
ds_write_b16 v92, v76
v_cmpx_lt_i32 vcc, 1, v53
ds_write_b16 v93, v77
v_cmpx_lt_i32 vcc, 2, v53
ds_write_b16 v94, v78
v_cmpx_lt_i32 vcc, 3, v53
ds_write_b16 v95, v79
s_mov_b64 exec, -1
P_PL_D:
s_lshl_b32 s64, s3, 3
v_add_u32 v72, s64, v126
v_add_u32 v73, s64, v127
v_lshlrev_b32 v74, 2, v72
v_lshlrev_b32 v75, 2, v73
v_lshrrev_b32 v78, 3, v1
v_add_u32 v78, s64, v78
s_movk_i32 s65, 160
v_mul_u32_u24 v3, s65, v78
s_movk_i32 s66, 100
v_cmp_gt_u32 vcc, s66, v73
s_mov_b64 s[70:71], vcc
s_movk_i32 s64, 1152
v_mul_u32_u24 v123, s64, v73
v_lshlrev_b32 v125, 5, v73
v_add_u32 v125, 41424, v125
v_add_u32 v123, v123, v2
v_add_u32 v123, 44752, v123
s_lshl_b32 s62, s3, 2
v_mov_b32 v76, s62
s_waitcnt lgkmcnt(0)
s_barrier
s_cmp_ge_u32 s3, 13
s_cbranch_scc1 F_HELP
s_setprio 3
ds_read_b32 v64, v76 offset:19264
ds_read_b32 v77, v75 offset:18752
ds_read_b32 v120, v74 offset:19328
ds_read_b32 v121, v74 offset:19344
ds_read_b32 v122, v75 offset:19328
v_mov_b32 v104, 0x7ffffff0
v_mov_b32 v105, 0x7ffffff0
v_mov_b32 v106, 0x7ffffff0
v_mov_b32 v107, 0x7ffffff0
v_mov_b32 v108, 0x7ffffff0
v_mov_b32 v109, 0x7ffffff0
v_mov_b32 v110, 0x7ffffff0
v_mov_b32 v111, 0x7ffffff0
v_mov_b32 v112, 0x7ffffff0
v_mov_b32 v113, 0x7ffffff0
v_mov_b32 v114, 0x7ffffff0
v_mov_b32 v115, 0x7ffffff0
v_mov_b32 v116, 0x7ffffff0
v_mov_b32 v117, 0x7ffffff0
v_mov_b32 v118, 0x7ffffff0
v_mov_b32 v119, 0x7ffffff0
s_mov_b32 s52, 1
s_mov_b32 s56, 0
s_mov_b32 s26, 3200000
s_mov_b32 s27, 0x00020000
s_mov_b32 s30, 3200000
s_mov_b32 s31, 0x00020000
s_add_u32 s28, s12, 0x800000
s_addc_u32 s29, s13, 0
s_mov_b32 s59, 0x1000000
v_mov_b32 v24, -1
v_mov_b32 v25, -1
v_mov_b32 v26, -1
v_mov_b32 v27, -1
s_mul_i32 s64, s2, 100
s_waitcnt lgkmcnt(0)
v_readfirstlane_b32 s65, v64
s_lshr_b32 s65, s65, 1
v_add_u32 v77, s64, v77
v_lshl_add_u32 v124, v77, 7, v2
s_max_u32 s65, s65, 1
s_min_u32 s65, s65, 80
s_sub_u32 s53, 80, s65
s_mov_b64 exec, s[70:71]
buffer_store_dwordx4 v[24:27], v124, s[20:23], s59 offen sc1
s_mov_b64 exec, -1
s_add_u32 s59, s59, 0x400000
P_HOP:
s_mov_b32 s24, s28
s_mov_b32 s25, s29
s_add_u32 s28, s28, 0x400000
s_addc_u32 s29, s29, 0
s_mov_b32 s73, 0
s_mov_b32 s93, 0
s_cmp_lg_u32 s75, 0
s_cbranch_scc1 P_SLOWG
v_mov_b32 v12, 0
v_mov_b32 v13, 0
v_mov_b32 v14, 0
v_mov_b32 v15, 0
v_mov_b32 v16, 0
v_mov_b32 v17, 0
v_mov_b32 v18, 0
v_mov_b32 v19, 0
s_andn2_b32 s87, s53, 15
s_and_b32 s88, s53, 15
s_add_u32 s90, s88, 15
s_and_b32 s90, s90, 15
s_lshl_b32 s63, s87, 1
v_add_u32 v20, s63, v3
s_lshr_b32 s64, s88, 3
s_lshl_b32 s64, s64, 5
v_add_u32 v21, s64, v20
ds_read_b128 v[24:27], v21
ds_read_b128 v[28:31], v20 offset:16
GW1:
ds_read_b32 v21, v22
s_waitcnt lgkmcnt(0)
v_readfirstlane_b32 s62, v21
s_cmp_ge_u32 s62, s56
s_cbranch_scc1 GW2
s_add_u32 s93, s93, 1
s_cmp_gt_u32 s93, 800000
s_cbranch_scc1 GW2
s_sleep 1
s_branch GW1
GW2:
s_cmp_ge_u32 s88, 8
s_cbranch_scc1 TR_1
s_cmp_ge_u32 s88, 4
s_cbranch_scc1 TR_2
s_cmp_ge_u32 s88, 2
s_cbranch_scc1 TR_3
s_cmp_ge_u32 s88, 1
s_cbranch_scc1 TR_4
s_branch PA_0
TR_4:
s_branch PA_1
TR_3:
s_cmp_ge_u32 s88, 3
s_cbranch_scc1 TR_5
s_branch PA_2
TR_5:
s_branch PA_3
TR_2:
s_cmp_ge_u32 s88, 6
s_cbranch_scc1 TR_6
s_cmp_ge_u32 s88, 5
s_cbranch_scc1 TR_7
s_branch PA_4
TR_7:
s_branch PA_5
TR_6:
s_cmp_ge_u32 s88, 7
s_cbranch_scc1 TR_8
s_branch PA_6
TR_8:
s_branch PA_7
TR_1:
s_cmp_ge_u32 s88, 12
s_cbranch_scc1 TR_9
s_cmp_ge_u32 s88, 10
s_cbranch_scc1 TR_10
s_cmp_ge_u32 s88, 9
s_cbranch_scc1 TR_11
s_branch PA_8
TR_11:
s_branch PA_9
TR_10:
s_cmp_ge_u32 s88, 11
s_cbranch_scc1 TR_12
s_branch PA_10
TR_12:
s_branch PA_11
TR_9:
s_cmp_ge_u32 s88, 14
s_cbranch_scc1 TR_13
s_cmp_ge_u32 s88, 13
s_cbranch_scc1 TR_14
s_branch PA_12
TR_14:
s_branch PA_13
TR_13:
s_cmp_ge_u32 s88, 15
s_cbranch_scc1 TR_15
s_branch PA_14
TR_15:
s_branch PA_15
PA_0:
s_waitcnt lgkmcnt(0)
ds_read_b128 v[28:31], v20 offset:16
v_mad_u32_u16 v104, v24, s74, v2 op_sel:[0,0,0,0]
buffer_load_dwordx4 v[40:43], v104, s[24:27], 0 offen sc1
s_cmp_eq_u32 s90, 0
s_cbranch_scc1 PB_1
PA_1:
v_mad_u32_u16 v105, v24, s74, v2 op_sel:[1,0,0,0]
buffer_load_dwordx4 v[44:47], v105, s[24:27], 0 offen sc1
s_cmp_eq_u32 s90, 1
s_cbranch_scc1 PB_2
PA_2:
v_mad_u32_u16 v106, v25, s74, v2 op_sel:[0,0,0,0]
buffer_load_dwordx4 v[48:51], v106, s[24:27], 0 offen sc1
s_cmp_eq_u32 s90, 2
s_cbranch_scc1 PB_3
PA_3:
v_mad_u32_u16 v107, v25, s74, v2 op_sel:[1,0,0,0]
buffer_load_dwordx4 v[52:55], v107, s[24:27], 0 offen sc1
s_cmp_eq_u32 s90, 3
s_cbranch_scc1 PB_4
PA_4:
v_mad_u32_u16 v108, v26, s74, v2 op_sel:[0,0,0,0]
buffer_load_dwordx4 v[56:59], v108, s[24:27], 0 offen sc1
s_cmp_eq_u32 s90, 4
s_cbranch_scc1 PB_5
PA_5:
v_mad_u32_u16 v109, v26, s74, v2 op_sel:[1,0,0,0]
buffer_load_dwordx4 v[60:63], v109, s[24:27], 0 offen sc1
s_cmp_eq_u32 s90, 5
s_cbranch_scc1 PB_6
PA_6:
v_mad_u32_u16 v110, v27, s74, v2 op_sel:[0,0,0,0]
buffer_load_dwordx4 v[64:67], v110, s[24:27], 0 offen sc1
s_cmp_eq_u32 s90, 6
s_cbranch_scc1 PB_7
PA_7:
v_mad_u32_u16 v111, v27, s74, v2 op_sel:[1,0,0,0]
buffer_load_dwordx4 v[68:71], v111, s[24:27], 0 offen sc1
s_cmp_eq_u32 s90, 7
s_cbranch_scc1 PB_8
PA_8:
s_waitcnt lgkmcnt(0)
ds_read_b128 v[24:27], v20 offset:32
v_mad_u32_u16 v112, v28, s74, v2 op_sel:[0,0,0,0]
buffer_load_dwordx4 v[72:75], v112, s[24:27], 0 offen sc1
s_cmp_eq_u32 s90, 8
s_cbranch_scc1 PB_9
PA_9:
v_mad_u32_u16 v113, v28, s74, v2 op_sel:[1,0,0,0]
buffer_load_dwordx4 v[76:79], v113, s[24:27], 0 offen sc1
s_cmp_eq_u32 s90, 9
s_cbranch_scc1 PB_10
PA_10:
v_mad_u32_u16 v114, v29, s74, v2 op_sel:[0,0,0,0]
buffer_load_dwordx4 v[80:83], v114, s[24:27], 0 offen sc1
s_cmp_eq_u32 s90, 10
s_cbranch_scc1 PB_11
PA_11:
v_mad_u32_u16 v115, v29, s74, v2 op_sel:[1,0,0,0]
buffer_load_dwordx4 v[84:87], v115, s[24:27], 0 offen sc1
s_cmp_eq_u32 s90, 11
s_cbranch_scc1 PB_12
PA_12:
v_mad_u32_u16 v116, v30, s74, v2 op_sel:[0,0,0,0]
buffer_load_dwordx4 v[88:91], v116, s[24:27], 0 offen sc1
s_cmp_eq_u32 s90, 12
s_cbranch_scc1 PB_13
PA_13:
v_mad_u32_u16 v117, v30, s74, v2 op_sel:[1,0,0,0]
buffer_load_dwordx4 v[92:95], v117, s[24:27], 0 offen sc1
s_cmp_eq_u32 s90, 13
s_cbranch_scc1 PB_14
PA_14:
v_mad_u32_u16 v118, v31, s74, v2 op_sel:[0,0,0,0]
buffer_load_dwordx4 v[96:99], v118, s[24:27], 0 offen sc1
s_cmp_eq_u32 s90, 14
s_cbranch_scc1 PB_15
PA_15:
v_mad_u32_u16 v119, v31, s74, v2 op_sel:[1,0,0,0]
buffer_load_dwordx4 v[100:103], v119, s[24:27], 0 offen sc1
s_cmp_eq_u32 s87, 64
s_cbranch_scc1 PA_END
s_add_u32 s87, s87, 16
v_add_u32 v20, 32, v20
s_cmp_eq_u32 s90, 15
s_cbranch_scc0 PA_0
PB_0:
s_waitcnt vmcnt(15)
v_max3_u32 v21, v40, v41, v42
v_max_u32 v21, v21, v43
v_cmp_eq_u32 vcc, -1, v21
s_cbranch_vccnz STB_0
RTB_0:
v_mfma_f32_16x16x32_bf16 v[12:15], v[4:7], v[40:43], v[12:15]
v_mfma_f32_16x16x32_bf16 v[16:19], v[8:11], v[40:43], v[16:19]
s_waitcnt lgkmcnt(0)
ds_read_b128 v[28:31], v20 offset:16
v_mad_u32_u16 v104, v24, s74, v2 op_sel:[0,0,0,0]
buffer_load_dwordx4 v[40:43], v104, s[24:27], 0 offen sc1
PB_1:
s_waitcnt vmcnt(15)
v_max3_u32 v21, v44, v45, v46
v_max_u32 v21, v21, v47
v_cmp_eq_u32 vcc, -1, v21
s_cbranch_vccnz STB_1
RTB_1:
v_mfma_f32_16x16x32_bf16 v[12:15], v[4:7], v[44:47], v[12:15]
v_mfma_f32_16x16x32_bf16 v[16:19], v[8:11], v[44:47], v[16:19]
v_mad_u32_u16 v105, v24, s74, v2 op_sel:[1,0,0,0]
buffer_load_dwordx4 v[44:47], v105, s[24:27], 0 offen sc1
PB_2:
s_waitcnt vmcnt(15)
v_max3_u32 v21, v48, v49, v50
v_max_u32 v21, v21, v51
v_cmp_eq_u32 vcc, -1, v21
s_cbranch_vccnz STB_2
RTB_2:
v_mfma_f32_16x16x32_bf16 v[12:15], v[4:7], v[48:51], v[12:15]
v_mfma_f32_16x16x32_bf16 v[16:19], v[8:11], v[48:51], v[16:19]
v_mad_u32_u16 v106, v25, s74, v2 op_sel:[0,0,0,0]
buffer_load_dwordx4 v[48:51], v106, s[24:27], 0 offen sc1
PB_3:
s_waitcnt vmcnt(15)
v_max3_u32 v21, v52, v53, v54
v_max_u32 v21, v21, v55
v_cmp_eq_u32 vcc, -1, v21
s_cbranch_vccnz STB_3
RTB_3:
v_mfma_f32_16x16x32_bf16 v[12:15], v[4:7], v[52:55], v[12:15]
v_mfma_f32_16x16x32_bf16 v[16:19], v[8:11], v[52:55], v[16:19]
v_mad_u32_u16 v107, v25, s74, v2 op_sel:[1,0,0,0]
buffer_load_dwordx4 v[52:55], v107, s[24:27], 0 offen sc1
PB_4:
s_waitcnt vmcnt(15)
v_max3_u32 v21, v56, v57, v58
v_max_u32 v21, v21, v59
v_cmp_eq_u32 vcc, -1, v21
s_cbranch_vccnz STB_4
RTB_4:
v_mfma_f32_16x16x32_bf16 v[12:15], v[4:7], v[56:59], v[12:15]
v_mfma_f32_16x16x32_bf16 v[16:19], v[8:11], v[56:59], v[16:19]
v_mad_u32_u16 v108, v26, s74, v2 op_sel:[0,0,0,0]
buffer_load_dwordx4 v[56:59], v108, s[24:27], 0 offen sc1
PB_5:
s_waitcnt vmcnt(15)
v_max3_u32 v21, v60, v61, v62
v_max_u32 v21, v21, v63
v_cmp_eq_u32 vcc, -1, v21
s_cbranch_vccnz STB_5
RTB_5:
v_mfma_f32_16x16x32_bf16 v[12:15], v[4:7], v[60:63], v[12:15]
v_mfma_f32_16x16x32_bf16 v[16:19], v[8:11], v[60:63], v[16:19]
v_mad_u32_u16 v109, v26, s74, v2 op_sel:[1,0,0,0]
buffer_load_dwordx4 v[60:63], v109, s[24:27], 0 offen sc1
PB_6:
s_waitcnt vmcnt(15)
v_max3_u32 v21, v64, v65, v66
v_max_u32 v21, v21, v67
v_cmp_eq_u32 vcc, -1, v21
s_cbranch_vccnz STB_6
RTB_6:
v_mfma_f32_16x16x32_bf16 v[12:15], v[4:7], v[64:67], v[12:15]
v_mfma_f32_16x16x32_bf16 v[16:19], v[8:11], v[64:67], v[16:19]
v_mad_u32_u16 v110, v27, s74, v2 op_sel:[0,0,0,0]
buffer_load_dwordx4 v[64:67], v110, s[24:27], 0 offen sc1
PB_7:
s_waitcnt vmcnt(15)
v_max3_u32 v21, v68, v69, v70
v_max_u32 v21, v21, v71
v_cmp_eq_u32 vcc, -1, v21
s_cbranch_vccnz STB_7
RTB_7:
v_mfma_f32_16x16x32_bf16 v[12:15], v[4:7], v[68:71], v[12:15]
v_mfma_f32_16x16x32_bf16 v[16:19], v[8:11], v[68:71], v[16:19]
v_mad_u32_u16 v111, v27, s74, v2 op_sel:[1,0,0,0]
buffer_load_dwordx4 v[68:71], v111, s[24:27], 0 offen sc1
PB_8:
s_waitcnt vmcnt(15)
v_max3_u32 v21, v72, v73, v74
v_max_u32 v21, v21, v75
v_cmp_eq_u32 vcc, -1, v21
s_cbranch_vccnz STB_8
RTB_8:
v_mfma_f32_16x16x32_bf16 v[12:15], v[4:7], v[72:75], v[12:15]
v_mfma_f32_16x16x32_bf16 v[16:19], v[8:11], v[72:75], v[16:19]
s_waitcnt lgkmcnt(0)
ds_read_b128 v[24:27], v20 offset:32
v_mad_u32_u16 v112, v28, s74, v2 op_sel:[0,0,0,0]
buffer_load_dwordx4 v[72:75], v112, s[24:27], 0 offen sc1
PB_9:
s_waitcnt vmcnt(15)
v_max3_u32 v21, v76, v77, v78
v_max_u32 v21, v21, v79
v_cmp_eq_u32 vcc, -1, v21
s_cbranch_vccnz STB_9
RTB_9:
v_mfma_f32_16x16x32_bf16 v[12:15], v[4:7], v[76:79], v[12:15]
v_mfma_f32_16x16x32_bf16 v[16:19], v[8:11], v[76:79], v[16:19]
v_mad_u32_u16 v113, v28, s74, v2 op_sel:[1,0,0,0]
buffer_load_dwordx4 v[76:79], v113, s[24:27], 0 offen sc1
PB_10:
s_waitcnt vmcnt(15)
v_max3_u32 v21, v80, v81, v82
v_max_u32 v21, v21, v83
v_cmp_eq_u32 vcc, -1, v21
s_cbranch_vccnz STB_10
RTB_10:
v_mfma_f32_16x16x32_bf16 v[12:15], v[4:7], v[80:83], v[12:15]
v_mfma_f32_16x16x32_bf16 v[16:19], v[8:11], v[80:83], v[16:19]
v_mad_u32_u16 v114, v29, s74, v2 op_sel:[0,0,0,0]
buffer_load_dwordx4 v[80:83], v114, s[24:27], 0 offen sc1
PB_11:
s_waitcnt vmcnt(15)
v_max3_u32 v21, v84, v85, v86
v_max_u32 v21, v21, v87
v_cmp_eq_u32 vcc, -1, v21
s_cbranch_vccnz STB_11
RTB_11:
v_mfma_f32_16x16x32_bf16 v[12:15], v[4:7], v[84:87], v[12:15]
v_mfma_f32_16x16x32_bf16 v[16:19], v[8:11], v[84:87], v[16:19]
v_mad_u32_u16 v115, v29, s74, v2 op_sel:[1,0,0,0]
buffer_load_dwordx4 v[84:87], v115, s[24:27], 0 offen sc1
PB_12:
s_waitcnt vmcnt(15)
v_max3_u32 v21, v88, v89, v90
v_max_u32 v21, v21, v91
v_cmp_eq_u32 vcc, -1, v21
s_cbranch_vccnz STB_12
RTB_12:
v_mfma_f32_16x16x32_bf16 v[12:15], v[4:7], v[88:91], v[12:15]
v_mfma_f32_16x16x32_bf16 v[16:19], v[8:11], v[88:91], v[16:19]
v_mad_u32_u16 v116, v30, s74, v2 op_sel:[0,0,0,0]
buffer_load_dwordx4 v[88:91], v116, s[24:27], 0 offen sc1
PB_13:
s_waitcnt vmcnt(15)
v_max3_u32 v21, v92, v93, v94
v_max_u32 v21, v21, v95
v_cmp_eq_u32 vcc, -1, v21
s_cbranch_vccnz STB_13
RTB_13:
v_mfma_f32_16x16x32_bf16 v[12:15], v[4:7], v[92:95], v[12:15]
v_mfma_f32_16x16x32_bf16 v[16:19], v[8:11], v[92:95], v[16:19]
v_mad_u32_u16 v117, v30, s74, v2 op_sel:[1,0,0,0]
buffer_load_dwordx4 v[92:95], v117, s[24:27], 0 offen sc1
PB_14:
s_waitcnt vmcnt(15)
v_max3_u32 v21, v96, v97, v98
v_max_u32 v21, v21, v99
v_cmp_eq_u32 vcc, -1, v21
s_cbranch_vccnz STB_14
RTB_14:
v_mfma_f32_16x16x32_bf16 v[12:15], v[4:7], v[96:99], v[12:15]
v_mfma_f32_16x16x32_bf16 v[16:19], v[8:11], v[96:99], v[16:19]
v_mad_u32_u16 v118, v31, s74, v2 op_sel:[0,0,0,0]
buffer_load_dwordx4 v[96:99], v118, s[24:27], 0 offen sc1
PB_15:
s_waitcnt vmcnt(15)
v_max3_u32 v21, v100, v101, v102
v_max_u32 v21, v21, v103
v_cmp_eq_u32 vcc, -1, v21
s_cbranch_vccnz STB_15
RTB_15:
v_mfma_f32_16x16x32_bf16 v[12:15], v[4:7], v[100:103], v[12:15]
v_mfma_f32_16x16x32_bf16 v[16:19], v[8:11], v[100:103], v[16:19]
v_mad_u32_u16 v119, v31, s74, v2 op_sel:[1,0,0,0]
buffer_load_dwordx4 v[100:103], v119, s[24:27], 0 offen sc1
s_add_u32 s87, s87, 16
v_add_u32 v20, 32, v20
s_cmp_lt_u32 s87, 80
s_cbranch_scc1 PB_0
PD_0:
s_waitcnt vmcnt(15)
v_max3_u32 v21, v40, v41, v42
v_max_u32 v21, v21, v43
v_cmp_eq_u32 vcc, -1, v21
s_cbranch_vccnz STD_0
RTD_0:
v_mfma_f32_16x16x32_bf16 v[12:15], v[4:7], v[40:43], v[12:15]
v_mfma_f32_16x16x32_bf16 v[16:19], v[8:11], v[40:43], v[16:19]
PD_1:
s_waitcnt vmcnt(14)
v_max3_u32 v21, v44, v45, v46
v_max_u32 v21, v21, v47
v_cmp_eq_u32 vcc, -1, v21
s_cbranch_vccnz STD_1
RTD_1:
v_mfma_f32_16x16x32_bf16 v[12:15], v[4:7], v[44:47], v[12:15]
v_mfma_f32_16x16x32_bf16 v[16:19], v[8:11], v[44:47], v[16:19]
PD_2:
s_waitcnt vmcnt(13)
v_max3_u32 v21, v48, v49, v50
v_max_u32 v21, v21, v51
v_cmp_eq_u32 vcc, -1, v21
s_cbranch_vccnz STD_2
RTD_2:
v_mfma_f32_16x16x32_bf16 v[12:15], v[4:7], v[48:51], v[12:15]
v_mfma_f32_16x16x32_bf16 v[16:19], v[8:11], v[48:51], v[16:19]
PD_3:
s_waitcnt vmcnt(12)
v_max3_u32 v21, v52, v53, v54
v_max_u32 v21, v21, v55
v_cmp_eq_u32 vcc, -1, v21
s_cbranch_vccnz STD_3
RTD_3:
v_mfma_f32_16x16x32_bf16 v[12:15], v[4:7], v[52:55], v[12:15]
v_mfma_f32_16x16x32_bf16 v[16:19], v[8:11], v[52:55], v[16:19]
PD_4:
s_waitcnt vmcnt(11)
v_max3_u32 v21, v56, v57, v58
v_max_u32 v21, v21, v59
v_cmp_eq_u32 vcc, -1, v21
s_cbranch_vccnz STD_4
RTD_4:
v_mfma_f32_16x16x32_bf16 v[12:15], v[4:7], v[56:59], v[12:15]
v_mfma_f32_16x16x32_bf16 v[16:19], v[8:11], v[56:59], v[16:19]
PD_5:
s_waitcnt vmcnt(10)
v_max3_u32 v21, v60, v61, v62
v_max_u32 v21, v21, v63
v_cmp_eq_u32 vcc, -1, v21
s_cbranch_vccnz STD_5
RTD_5:
v_mfma_f32_16x16x32_bf16 v[12:15], v[4:7], v[60:63], v[12:15]
v_mfma_f32_16x16x32_bf16 v[16:19], v[8:11], v[60:63], v[16:19]
PD_6:
s_waitcnt vmcnt(9)
v_max3_u32 v21, v64, v65, v66
v_max_u32 v21, v21, v67
v_cmp_eq_u32 vcc, -1, v21
s_cbranch_vccnz STD_6
RTD_6:
v_mfma_f32_16x16x32_bf16 v[12:15], v[4:7], v[64:67], v[12:15]
v_mfma_f32_16x16x32_bf16 v[16:19], v[8:11], v[64:67], v[16:19]
PD_7:
s_waitcnt vmcnt(8)
v_max3_u32 v21, v68, v69, v70
v_max_u32 v21, v21, v71
v_cmp_eq_u32 vcc, -1, v21
s_cbranch_vccnz STD_7
RTD_7:
v_mfma_f32_16x16x32_bf16 v[12:15], v[4:7], v[68:71], v[12:15]
v_mfma_f32_16x16x32_bf16 v[16:19], v[8:11], v[68:71], v[16:19]
PD_8:
s_waitcnt vmcnt(7)
v_max3_u32 v21, v72, v73, v74
v_max_u32 v21, v21, v75
v_cmp_eq_u32 vcc, -1, v21
s_cbranch_vccnz STD_8
RTD_8:
v_mfma_f32_16x16x32_bf16 v[12:15], v[4:7], v[72:75], v[12:15]
v_mfma_f32_16x16x32_bf16 v[16:19], v[8:11], v[72:75], v[16:19]
PD_9:
s_waitcnt vmcnt(6)
v_max3_u32 v21, v76, v77, v78
v_max_u32 v21, v21, v79
v_cmp_eq_u32 vcc, -1, v21
s_cbranch_vccnz STD_9
RTD_9:
v_mfma_f32_16x16x32_bf16 v[12:15], v[4:7], v[76:79], v[12:15]
v_mfma_f32_16x16x32_bf16 v[16:19], v[8:11], v[76:79], v[16:19]
PD_10:
s_waitcnt vmcnt(5)
v_max3_u32 v21, v80, v81, v82
v_max_u32 v21, v21, v83
v_cmp_eq_u32 vcc, -1, v21
s_cbranch_vccnz STD_10
RTD_10:
v_mfma_f32_16x16x32_bf16 v[12:15], v[4:7], v[80:83], v[12:15]
v_mfma_f32_16x16x32_bf16 v[16:19], v[8:11], v[80:83], v[16:19]
PD_11:
s_waitcnt vmcnt(4)
v_max3_u32 v21, v84, v85, v86
v_max_u32 v21, v21, v87
v_cmp_eq_u32 vcc, -1, v21
s_cbranch_vccnz STD_11
RTD_11:
v_mfma_f32_16x16x32_bf16 v[12:15], v[4:7], v[84:87], v[12:15]
v_mfma_f32_16x16x32_bf16 v[16:19], v[8:11], v[84:87], v[16:19]
PD_12:
s_waitcnt vmcnt(3)
v_max3_u32 v21, v88, v89, v90
v_max_u32 v21, v21, v91
v_cmp_eq_u32 vcc, -1, v21
s_cbranch_vccnz STD_12
RTD_12:
v_mfma_f32_16x16x32_bf16 v[12:15], v[4:7], v[88:91], v[12:15]
v_mfma_f32_16x16x32_bf16 v[16:19], v[8:11], v[88:91], v[16:19]
PD_13:
s_waitcnt vmcnt(2)
v_max3_u32 v21, v92, v93, v94
v_max_u32 v21, v21, v95
v_cmp_eq_u32 vcc, -1, v21
s_cbranch_vccnz STD_13
RTD_13:
v_mfma_f32_16x16x32_bf16 v[12:15], v[4:7], v[92:95], v[12:15]
v_mfma_f32_16x16x32_bf16 v[16:19], v[8:11], v[92:95], v[16:19]
PD_14:
s_waitcnt vmcnt(1)
v_max3_u32 v21, v96, v97, v98
v_max_u32 v21, v21, v99
v_cmp_eq_u32 vcc, -1, v21
s_cbranch_vccnz STD_14
RTD_14:
v_mfma_f32_16x16x32_bf16 v[12:15], v[4:7], v[96:99], v[12:15]
v_mfma_f32_16x16x32_bf16 v[16:19], v[8:11], v[96:99], v[16:19]
PD_15:
s_waitcnt vmcnt(0)
v_max3_u32 v21, v100, v101, v102
v_max_u32 v21, v21, v103
v_cmp_eq_u32 vcc, -1, v21
s_cbranch_vccnz STD_15
RTD_15:
v_mfma_f32_16x16x32_bf16 v[12:15], v[4:7], v[100:103], v[12:15]
v_mfma_f32_16x16x32_bf16 v[16:19], v[8:11], v[100:103], v[16:19]
s_branch P_FLUSH
PA_END:
s_cmp_ge_u32 s88, 8
s_cbranch_scc1 TR_16
s_cmp_ge_u32 s88, 4
s_cbranch_scc1 TR_17
s_cmp_ge_u32 s88, 2
s_cbranch_scc1 TR_18
s_cmp_ge_u32 s88, 1
s_cbranch_scc1 TR_19
s_branch PD_0
TR_19:
s_branch PD_1
TR_18:
s_cmp_ge_u32 s88, 3
s_cbranch_scc1 TR_20
s_branch PD_2
TR_20:
s_branch PD_3
TR_17:
s_cmp_ge_u32 s88, 6
s_cbranch_scc1 TR_21
s_cmp_ge_u32 s88, 5
s_cbranch_scc1 TR_22
s_branch PD_4
TR_22:
s_branch PD_5
TR_21:
s_cmp_ge_u32 s88, 7
s_cbranch_scc1 TR_23
s_branch PD_6
TR_23:
s_branch PD_7
TR_16:
s_cmp_ge_u32 s88, 12
s_cbranch_scc1 TR_24
s_cmp_ge_u32 s88, 10
s_cbranch_scc1 TR_25
s_cmp_ge_u32 s88, 9
s_cbranch_scc1 TR_26
s_branch PD_8
TR_26:
s_branch PD_9
TR_25:
s_cmp_ge_u32 s88, 11
s_cbranch_scc1 TR_27
s_branch PD_10
TR_27:
s_branch PD_11
TR_24:
s_cmp_ge_u32 s88, 14
s_cbranch_scc1 TR_28
s_cmp_ge_u32 s88, 13
s_cbranch_scc1 TR_29
s_branch PD_12
TR_29:
s_branch PD_13
TR_28:
s_cmp_ge_u32 s88, 15
s_cbranch_scc1 TR_30
s_branch PD_14
TR_30:
s_branch PD_15
STB_0:
s_call_b64 s[76:77], POLL_0
s_branch RTB_0
STD_0:
s_call_b64 s[76:77], POLL_0
s_branch RTD_0
STB_1:
s_call_b64 s[76:77], POLL_1
s_branch RTB_1
STD_1:
s_call_b64 s[76:77], POLL_1
s_branch RTD_1
STB_2:
s_call_b64 s[76:77], POLL_2
s_branch RTB_2
STD_2:
s_call_b64 s[76:77], POLL_2
s_branch RTD_2
STB_3:
s_call_b64 s[76:77], POLL_3
s_branch RTB_3
STD_3:
s_call_b64 s[76:77], POLL_3
s_branch RTD_3
STB_4:
s_call_b64 s[76:77], POLL_4
s_branch RTB_4
STD_4:
s_call_b64 s[76:77], POLL_4
s_branch RTD_4
STB_5:
s_call_b64 s[76:77], POLL_5
s_branch RTB_5
STD_5:
s_call_b64 s[76:77], POLL_5
s_branch RTD_5
STB_6:
s_call_b64 s[76:77], POLL_6
s_branch RTB_6
STD_6:
s_call_b64 s[76:77], POLL_6
s_branch RTD_6
STB_7:
s_call_b64 s[76:77], POLL_7
s_branch RTB_7
STD_7:
s_call_b64 s[76:77], POLL_7
s_branch RTD_7
STB_8:
s_call_b64 s[76:77], POLL_8
s_branch RTB_8
STD_8:
s_call_b64 s[76:77], POLL_8
s_branch RTD_8
STB_9:
s_call_b64 s[76:77], POLL_9
s_branch RTB_9
STD_9:
s_call_b64 s[76:77], POLL_9
s_branch RTD_9
STB_10:
s_call_b64 s[76:77], POLL_10
s_branch RTB_10
STD_10:
s_call_b64 s[76:77], POLL_10
s_branch RTD_10
STB_11:
s_call_b64 s[76:77], POLL_11
s_branch RTB_11
STD_11:
s_call_b64 s[76:77], POLL_11
s_branch RTD_11
STB_12:
s_call_b64 s[76:77], POLL_12
s_branch RTB_12
STD_12:
s_call_b64 s[76:77], POLL_12
s_branch RTD_12
STB_13:
s_call_b64 s[76:77], POLL_13
s_branch RTB_13
STD_13:
s_call_b64 s[76:77], POLL_13
s_branch RTD_13
STB_14:
s_call_b64 s[76:77], POLL_14
s_branch RTB_14
STD_14:
s_call_b64 s[76:77], POLL_14
s_branch RTD_14
STB_15:
s_call_b64 s[76:77], POLL_15
s_branch RTB_15
STD_15:
s_call_b64 s[76:77], POLL_15
s_branch RTD_15
POLL_0:
s_add_u32 s73, s73, 1
s_cmp_gt_u32 s73, 200000
s_cbranch_scc1 P_RET
s_sleep 2
s_mov_b64 exec, vcc
buffer_load_dwordx4 v[40:43], v104, s[24:27], 0 offen sc1
s_mov_b64 exec, -1
s_waitcnt vmcnt(0)
v_max3_u32 v21, v40, v41, v42
v_max_u32 v21, v21, v43
v_cmp_eq_u32 vcc, -1, v21
s_cbranch_vccnz POLL_0
s_branch P_REFRESH
POLL_1:
s_add_u32 s73, s73, 1
s_cmp_gt_u32 s73, 200000
s_cbranch_scc1 P_RET
s_sleep 2
s_mov_b64 exec, vcc
buffer_load_dwordx4 v[44:47], v105, s[24:27], 0 offen sc1
s_mov_b64 exec, -1
s_waitcnt vmcnt(0)
v_max3_u32 v21, v44, v45, v46
v_max_u32 v21, v21, v47
v_cmp_eq_u32 vcc, -1, v21
s_cbranch_vccnz POLL_1
s_branch P_REFRESH
POLL_2:
s_add_u32 s73, s73, 1
s_cmp_gt_u32 s73, 200000
s_cbranch_scc1 P_RET
s_sleep 2
s_mov_b64 exec, vcc
buffer_load_dwordx4 v[48:51], v106, s[24:27], 0 offen sc1
s_mov_b64 exec, -1
s_waitcnt vmcnt(0)
v_max3_u32 v21, v48, v49, v50
v_max_u32 v21, v21, v51
v_cmp_eq_u32 vcc, -1, v21
s_cbranch_vccnz POLL_2
s_branch P_REFRESH
POLL_3:
s_add_u32 s73, s73, 1
s_cmp_gt_u32 s73, 200000
s_cbranch_scc1 P_RET
s_sleep 2
s_mov_b64 exec, vcc
buffer_load_dwordx4 v[52:55], v107, s[24:27], 0 offen sc1
s_mov_b64 exec, -1
s_waitcnt vmcnt(0)
v_max3_u32 v21, v52, v53, v54
v_max_u32 v21, v21, v55
v_cmp_eq_u32 vcc, -1, v21
s_cbranch_vccnz POLL_3
s_branch P_REFRESH
POLL_4:
s_add_u32 s73, s73, 1
s_cmp_gt_u32 s73, 200000
s_cbranch_scc1 P_RET
s_sleep 2
s_mov_b64 exec, vcc
buffer_load_dwordx4 v[56:59], v108, s[24:27], 0 offen sc1
s_mov_b64 exec, -1
s_waitcnt vmcnt(0)
v_max3_u32 v21, v56, v57, v58
v_max_u32 v21, v21, v59
v_cmp_eq_u32 vcc, -1, v21
s_cbranch_vccnz POLL_4
s_branch P_REFRESH
POLL_5:
s_add_u32 s73, s73, 1
s_cmp_gt_u32 s73, 200000
s_cbranch_scc1 P_RET
s_sleep 2
s_mov_b64 exec, vcc
buffer_load_dwordx4 v[60:63], v109, s[24:27], 0 offen sc1
s_mov_b64 exec, -1
s_waitcnt vmcnt(0)
v_max3_u32 v21, v60, v61, v62
v_max_u32 v21, v21, v63
v_cmp_eq_u32 vcc, -1, v21
s_cbranch_vccnz POLL_5
s_branch P_REFRESH
POLL_6:
s_add_u32 s73, s73, 1
s_cmp_gt_u32 s73, 200000
s_cbranch_scc1 P_RET
s_sleep 2
s_mov_b64 exec, vcc
buffer_load_dwordx4 v[64:67], v110, s[24:27], 0 offen sc1
s_mov_b64 exec, -1
s_waitcnt vmcnt(0)
v_max3_u32 v21, v64, v65, v66
v_max_u32 v21, v21, v67
v_cmp_eq_u32 vcc, -1, v21
s_cbranch_vccnz POLL_6
s_branch P_REFRESH
POLL_7:
s_add_u32 s73, s73, 1
s_cmp_gt_u32 s73, 200000
s_cbranch_scc1 P_RET
s_sleep 2
s_mov_b64 exec, vcc
buffer_load_dwordx4 v[68:71], v111, s[24:27], 0 offen sc1
s_mov_b64 exec, -1
s_waitcnt vmcnt(0)
v_max3_u32 v21, v68, v69, v70
v_max_u32 v21, v21, v71
v_cmp_eq_u32 vcc, -1, v21
s_cbranch_vccnz POLL_7
s_branch P_REFRESH
POLL_8:
s_add_u32 s73, s73, 1
s_cmp_gt_u32 s73, 200000
s_cbranch_scc1 P_RET
s_sleep 2
s_mov_b64 exec, vcc
buffer_load_dwordx4 v[72:75], v112, s[24:27], 0 offen sc1
s_mov_b64 exec, -1
s_waitcnt vmcnt(0)
v_max3_u32 v21, v72, v73, v74
v_max_u32 v21, v21, v75
v_cmp_eq_u32 vcc, -1, v21
s_cbranch_vccnz POLL_8
s_branch P_REFRESH
POLL_9:
s_add_u32 s73, s73, 1
s_cmp_gt_u32 s73, 200000
s_cbranch_scc1 P_RET
s_sleep 2
s_mov_b64 exec, vcc
buffer_load_dwordx4 v[76:79], v113, s[24:27], 0 offen sc1
s_mov_b64 exec, -1
s_waitcnt vmcnt(0)
v_max3_u32 v21, v76, v77, v78
v_max_u32 v21, v21, v79
v_cmp_eq_u32 vcc, -1, v21
s_cbranch_vccnz POLL_9
s_branch P_REFRESH
POLL_10:
s_add_u32 s73, s73, 1
s_cmp_gt_u32 s73, 200000
s_cbranch_scc1 P_RET
s_sleep 2
s_mov_b64 exec, vcc
buffer_load_dwordx4 v[80:83], v114, s[24:27], 0 offen sc1
s_mov_b64 exec, -1
s_waitcnt vmcnt(0)
v_max3_u32 v21, v80, v81, v82
v_max_u32 v21, v21, v83
v_cmp_eq_u32 vcc, -1, v21
s_cbranch_vccnz POLL_10
s_branch P_REFRESH
POLL_11:
s_add_u32 s73, s73, 1
s_cmp_gt_u32 s73, 200000
s_cbranch_scc1 P_RET
s_sleep 2
s_mov_b64 exec, vcc
buffer_load_dwordx4 v[84:87], v115, s[24:27], 0 offen sc1
s_mov_b64 exec, -1
s_waitcnt vmcnt(0)
v_max3_u32 v21, v84, v85, v86
v_max_u32 v21, v21, v87
v_cmp_eq_u32 vcc, -1, v21
s_cbranch_vccnz POLL_11
s_branch P_REFRESH
POLL_12:
s_add_u32 s73, s73, 1
s_cmp_gt_u32 s73, 200000
s_cbranch_scc1 P_RET
s_sleep 2
s_mov_b64 exec, vcc
buffer_load_dwordx4 v[88:91], v116, s[24:27], 0 offen sc1
s_mov_b64 exec, -1
s_waitcnt vmcnt(0)
v_max3_u32 v21, v88, v89, v90
v_max_u32 v21, v21, v91
v_cmp_eq_u32 vcc, -1, v21
s_cbranch_vccnz POLL_12
s_branch P_REFRESH
POLL_13:
s_add_u32 s73, s73, 1
s_cmp_gt_u32 s73, 200000
s_cbranch_scc1 P_RET
s_sleep 2
s_mov_b64 exec, vcc
buffer_load_dwordx4 v[92:95], v117, s[24:27], 0 offen sc1
s_mov_b64 exec, -1
s_waitcnt vmcnt(0)
v_max3_u32 v21, v92, v93, v94
v_max_u32 v21, v21, v95
v_cmp_eq_u32 vcc, -1, v21
s_cbranch_vccnz POLL_13
s_branch P_REFRESH
POLL_14:
s_add_u32 s73, s73, 1
s_cmp_gt_u32 s73, 200000
s_cbranch_scc1 P_RET
s_sleep 2
s_mov_b64 exec, vcc
buffer_load_dwordx4 v[96:99], v118, s[24:27], 0 offen sc1
s_mov_b64 exec, -1
s_waitcnt vmcnt(0)
v_max3_u32 v21, v96, v97, v98
v_max_u32 v21, v21, v99
v_cmp_eq_u32 vcc, -1, v21
s_cbranch_vccnz POLL_14
s_branch P_REFRESH
POLL_15:
s_add_u32 s73, s73, 1
s_cmp_gt_u32 s73, 200000
s_cbranch_scc1 P_RET
s_sleep 2
s_mov_b64 exec, vcc
buffer_load_dwordx4 v[100:103], v119, s[24:27], 0 offen sc1
s_mov_b64 exec, -1
s_waitcnt vmcnt(0)
v_max3_u32 v21, v100, v101, v102
v_max_u32 v21, v21, v103
v_cmp_eq_u32 vcc, -1, v21
s_cbranch_vccnz POLL_15
P_REFRESH:
v_max3_u32 v21, v40, v41, v42
v_max_u32 v21, v21, v43
v_cmp_eq_u32 vcc, -1, v21
s_cbranch_vccz RF_31
s_mov_b64 exec, vcc
buffer_load_dwordx4 v[40:43], v104, s[24:27], 0 offen sc1
s_mov_b64 exec, -1
RF_31:
v_max3_u32 v21, v44, v45, v46
v_max_u32 v21, v21, v47
v_cmp_eq_u32 vcc, -1, v21
s_cbranch_vccz RF_32
s_mov_b64 exec, vcc
buffer_load_dwordx4 v[44:47], v105, s[24:27], 0 offen sc1
s_mov_b64 exec, -1
RF_32:
v_max3_u32 v21, v48, v49, v50
v_max_u32 v21, v21, v51
v_cmp_eq_u32 vcc, -1, v21
s_cbranch_vccz RF_33
s_mov_b64 exec, vcc
buffer_load_dwordx4 v[48:51], v106, s[24:27], 0 offen sc1
s_mov_b64 exec, -1
RF_33:
v_max3_u32 v21, v52, v53, v54
v_max_u32 v21, v21, v55
v_cmp_eq_u32 vcc, -1, v21
s_cbranch_vccz RF_34
s_mov_b64 exec, vcc
buffer_load_dwordx4 v[52:55], v107, s[24:27], 0 offen sc1
s_mov_b64 exec, -1
RF_34:
v_max3_u32 v21, v56, v57, v58
v_max_u32 v21, v21, v59
v_cmp_eq_u32 vcc, -1, v21
s_cbranch_vccz RF_35
s_mov_b64 exec, vcc
buffer_load_dwordx4 v[56:59], v108, s[24:27], 0 offen sc1
s_mov_b64 exec, -1
RF_35:
v_max3_u32 v21, v60, v61, v62
v_max_u32 v21, v21, v63
v_cmp_eq_u32 vcc, -1, v21
s_cbranch_vccz RF_36
s_mov_b64 exec, vcc
buffer_load_dwordx4 v[60:63], v109, s[24:27], 0 offen sc1
s_mov_b64 exec, -1
RF_36:
v_max3_u32 v21, v64, v65, v66
v_max_u32 v21, v21, v67
v_cmp_eq_u32 vcc, -1, v21
s_cbranch_vccz RF_37
s_mov_b64 exec, vcc
buffer_load_dwordx4 v[64:67], v110, s[24:27], 0 offen sc1
s_mov_b64 exec, -1
RF_37:
v_max3_u32 v21, v68, v69, v70
v_max_u32 v21, v21, v71
v_cmp_eq_u32 vcc, -1, v21
s_cbranch_vccz RF_38
s_mov_b64 exec, vcc
buffer_load_dwordx4 v[68:71], v111, s[24:27], 0 offen sc1
s_mov_b64 exec, -1
RF_38:
v_max3_u32 v21, v72, v73, v74
v_max_u32 v21, v21, v75
v_cmp_eq_u32 vcc, -1, v21
s_cbranch_vccz RF_39
s_mov_b64 exec, vcc
buffer_load_dwordx4 v[72:75], v112, s[24:27], 0 offen sc1
s_mov_b64 exec, -1
RF_39:
v_max3_u32 v21, v76, v77, v78
v_max_u32 v21, v21, v79
v_cmp_eq_u32 vcc, -1, v21
s_cbranch_vccz RF_40
s_mov_b64 exec, vcc
buffer_load_dwordx4 v[76:79], v113, s[24:27], 0 offen sc1
s_mov_b64 exec, -1
RF_40:
v_max3_u32 v21, v80, v81, v82
v_max_u32 v21, v21, v83
v_cmp_eq_u32 vcc, -1, v21
s_cbranch_vccz RF_41
s_mov_b64 exec, vcc
buffer_load_dwordx4 v[80:83], v114, s[24:27], 0 offen sc1
s_mov_b64 exec, -1
RF_41:
v_max3_u32 v21, v84, v85, v86
v_max_u32 v21, v21, v87
v_cmp_eq_u32 vcc, -1, v21
s_cbranch_vccz RF_42
s_mov_b64 exec, vcc
buffer_load_dwordx4 v[84:87], v115, s[24:27], 0 offen sc1
s_mov_b64 exec, -1
RF_42:
v_max3_u32 v21, v88, v89, v90
v_max_u32 v21, v21, v91
v_cmp_eq_u32 vcc, -1, v21
s_cbranch_vccz RF_43
s_mov_b64 exec, vcc
buffer_load_dwordx4 v[88:91], v116, s[24:27], 0 offen sc1
s_mov_b64 exec, -1
RF_43:
v_max3_u32 v21, v92, v93, v94
v_max_u32 v21, v21, v95
v_cmp_eq_u32 vcc, -1, v21
s_cbranch_vccz RF_44
s_mov_b64 exec, vcc
buffer_load_dwordx4 v[92:95], v117, s[24:27], 0 offen sc1
s_mov_b64 exec, -1
RF_44:
v_max3_u32 v21, v96, v97, v98
v_max_u32 v21, v21, v99
v_cmp_eq_u32 vcc, -1, v21
s_cbranch_vccz RF_45
s_mov_b64 exec, vcc
buffer_load_dwordx4 v[96:99], v118, s[24:27], 0 offen sc1
s_mov_b64 exec, -1
RF_45:
v_max3_u32 v21, v100, v101, v102
v_max_u32 v21, v21, v103
v_cmp_eq_u32 vcc, -1, v21
s_cbranch_vccz RF_46
s_mov_b64 exec, vcc
buffer_load_dwordx4 v[100:103], v119, s[24:27], 0 offen sc1
s_mov_b64 exec, -1
RF_46:
s_waitcnt vmcnt(0)
P_RET:
s_setpc_b64 s[76:77]
P_FLUSH:
s_nop 5
v_mul_f32 v12, v12, v120
v_mul_f32 v16, v16, v121
v_mul_f32 v13, v13, v120
v_mul_f32 v17, v17, v121
v_mul_f32 v14, v14, v120
v_mul_f32 v18, v18, v121
v_mul_f32 v15, v15, v120
v_mul_f32 v19, v19, v121
v_cvt_pk_bf16_f32 v40, v12, v13
v_cvt_pk_bf16_f32 v41, v14, v15
v_cvt_pk_bf16_f32 v42, v16, v17
v_cvt_pk_bf16_f32 v43, v18, v19
s_nop 0
v_permlane16_swap_b32 v40, v42
v_permlane16_swap_b32 v41, v43
s_mov_b64 exec, s[70:71]
s_cmp_eq_u32 s52, 7
s_cbranch_scc1 P_NOG
v_lshlrev_b32 v48, 16, v40
v_and_b32 v49, 0xffff0000, v40
v_mul_f32 v48, v48, v122
v_mul_f32 v49, v49, v122
v_cvt_pk_bf16_f32 v44, v48, v49
v_min_u32 v44, -2, v44
v_lshlrev_b32 v48, 16, v41
v_and_b32 v49, 0xffff0000, v41
v_mul_f32 v48, v48, v122
v_mul_f32 v49, v49, v122
v_cvt_pk_bf16_f32 v45, v48, v49
v_min_u32 v45, -2, v45
v_lshlrev_b32 v48, 16, v42
v_and_b32 v49, 0xffff0000, v42
v_mul_f32 v48, v48, v122
v_mul_f32 v49, v49, v122
v_cvt_pk_bf16_f32 v46, v48, v49
v_min_u32 v46, -2, v46
v_lshlrev_b32 v48, 16, v43
v_and_b32 v49, 0xffff0000, v43
v_mul_f32 v48, v48, v122
v_mul_f32 v49, v49, v122
v_cvt_pk_bf16_f32 v47, v48, v49
v_min_u32 v47, -2, v47
buffer_store_dwordx4 v[44:47], v124, s[28:31], 0 offen sc1
s_mov_b64 exec, 1
v_mov_b32 v52, 1
ds_add_u32 v22, v52
s_mov_b64 exec, s[70:71]
s_cmp_gt_u32 s52, 4
s_cbranch_scc1 P_NOG
v_mov_b32 v24, -1
v_mov_b32 v25, -1
v_mov_b32 v26, -1
v_mov_b32 v27, -1
buffer_store_dwordx4 v[24:27], v124, s[20:23], s59 offen sc1
s_add_u32 s59, s59, 0x400000
P_NOG:
s_mul_i32 s62, s52, 144
v_add_u32 v50, s62, v123
ds_write_b128 v50, v[40:43]
v_add_u32 v125, 4, v125
v_dot2_f32_bf16 v52, v40, v40, 0
v_dot2_f32_bf16 v53, v40, s99, 0
v_dot2_f32_bf16 v52, v41, v41, v52
v_dot2_f32_bf16 v53, v41, s99, v53
v_dot2_f32_bf16 v52, v42, v42, v52
v_dot2_f32_bf16 v53, v42, s99, v53
v_dot2_f32_bf16 v52, v43, v43, v52
v_dot2_f32_bf16 v53, v43, s99, v53
s_nop 1
v_add_f32_dpp v52, v52, v52 quad_perm:[1,0,3,2] row_mask:0xf bank_mask:0xf
v_add_f32_dpp v53, v53, v53 quad_perm:[1,0,3,2] row_mask:0xf bank_mask:0xf
s_nop 0
v_add_f32_dpp v52, v52, v52 quad_perm:[2,3,0,1] row_mask:0xf bank_mask:0xf
v_add_f32_dpp v53, v53, v53 quad_perm:[2,3,0,1] row_mask:0xf bank_mask:0xf
s_nop 0
v_add_f32_dpp v52, v52, v52 row_half_mirror row_mask:0xf bank_mask:0xf
v_add_f32_dpp v53, v53, v53 row_half_mirror row_mask:0xf bank_mask:0xf
v_mul_f32 v53, 0x3c800000, v53
v_mul_f32 v54, v53, v53
v_mul_f32 v52, 0x3c800000, v52
v_sub_f32 v52, v52, v54
v_max_f32 v52, 0, v52
v_add_f32 v52, 0x3727c5ac, v52
v_rsq_f32 v52, v52
s_nop 0
ds_write_b32 v125, v52
s_mov_b64 exec, -1
s_add_u32 s56, s56, 13
s_add_u32 s52, s52, 1
s_cmp_le_u32 s52, 7
s_cbranch_scc1 P_HOP
s_waitcnt lgkmcnt(0)
s_lshl_b32 s62, 1, s3
v_mov_b32 v0, 19876
v_mov_b32 v1, s62
s_mov_b64 exec, 1
ds_or_b32 v0, v1
s_mov_b64 exec, -1
s_setprio 0
F_SETUP:
v_mbcnt_lo_u32_b32 v20, -1, 0
v_mbcnt_hi_u32_b32 v20, -1, v20
v_lshlrev_b32 v32, 4, v20
v_add_u32 v32, 19904, v32
v_mov_b32 v33, 19876
ds_read_b32 v35, v33
ds_read_b128 v[64:67], v32 offset:0
ds_read_b128 v[68:71], v32 offset:1024
ds_read_b128 v[72:75], v32 offset:2048
ds_read_b128 v[76:79], v32 offset:3072
ds_read_b128 v[80:83], v32 offset:4096
ds_read_b128 v[84:87], v32 offset:5120
ds_read_b128 v[88:91], v32 offset:6144
ds_read_b128 v[92:95], v32 offset:7168
ds_read_b128 v[96:99], v32 offset:8192
ds_read_b128 v[100:103], v32 offset:9216
ds_read_b128 v[104:107], v32 offset:10240
ds_read_b128 v[108:111], v32 offset:11264
ds_read_b128 v[112:115], v32 offset:12288
ds_read_b128 v[116:119], v32 offset:13312
ds_read_b128 v[120:123], v32 offset:14336
ds_read_b128 v[124:127], v32 offset:15360
ds_read_b128 v[12:15], v32 offset:16384
ds_read_b128 v[16:19], v32 offset:17408
v_mov_b32 v33, 38336
ds_read_b32 v34, v33
ds_read_b128 v[0:3], v32 offset:18448
ds_read_b128 v[4:7], v32 offset:19472
ds_read_b128 v[8:11], v32 offset:20496
s_mov_b32 s78, 0x00ff00ff
s_mov_b32 s79, 0xff00ff00
s_mov_b32 s80, 0x3c800000
s_mov_b32 s81, 0x3727c5ac
s_mov_b32 s82, 0xffff0000
s_mov_b32 s83, 0x3fb8aa3b
s_mul_i32 s84, s2, 12800
s_waitcnt lgkmcnt(0)
v_readfirstlane_b32 s86, v34
v_readfirstlane_b32 s62, v35
s_bitcmp1_b32 s62, 15
s_cbranch_scc1 F_NEXT
s_sleep 4
s_branch F_SETUP
F_NEXT:
s_mov_b64 exec, 1
ds_inc_rtn_u32 v60, v3, v3 offset:1120
F_POLL:
ds_read_b32 v61, v3 offset:1124
s_mov_b64 exec, -1
s_waitcnt lgkmcnt(0)
v_readfirstlane_b32 s88, v60
v_readfirstlane_b32 s89, v61
s_cmp_ge_u32 s88, 50
s_cbranch_scc1 F_DONE
s_lshr_b32 s62, s88, 2
s_bitcmp1_b32 s89, s62
s_cbranch_scc1 F_GO
s_sleep 2
s_mov_b64 exec, 1
s_branch F_POLL
F_GO:
s_mul_i32 s62, s88, 2304
s_lshl_b32 s63, s88, 6
s_lshl_b32 s64, s88, 3
v_add_u32 v60, s62, v0
ds_read_b128 v[20:23], v60
ds_read_b128 v[24:27], v60 offset:16
v_add_u32 v61, s63, v2
ds_read_b128 v[52:55], v61
v_add_u32 v62, s63, v1
ds_read_b32 v56, v62
v_add_u32 v63, s64, v3
ds_read_b32 v58, v63
s_waitcnt lgkmcnt(3)
v_mfma_f32_16x16x32_bf16 v[36:39], v[64:67], v[20:23], 0
v_mfma_f32_16x16x32_bf16 v[40:43], v[72:75], v[20:23], 0
v_mfma_f32_16x16x32_bf16 v[44:47], v[80:83], v[20:23], 0
v_mfma_f32_16x16x32_bf16 v[48:51], v[88:91], v[20:23], 0
v_mfma_f32_16x16x32_bf16 v[36:39], v[68:71], v[24:27], v[36:39]
v_mfma_f32_16x16x32_bf16 v[40:43], v[76:79], v[24:27], v[40:43]
v_mfma_f32_16x16x32_bf16 v[44:47], v[84:87], v[24:27], v[44:47]
v_mfma_f32_16x16x32_bf16 v[48:51], v[92:95], v[24:27], v[48:51]
s_nop 4
v_cvt_pk_bf16_f32 v28, v36, v37
v_cvt_pk_bf16_f32 v29, v38, v39
v_cvt_pk_bf16_f32 v30, v40, v41
v_cvt_pk_bf16_f32 v31, v42, v43
v_cvt_pk_bf16_f32 v32, v44, v45
v_cvt_pk_bf16_f32 v33, v46, v47
v_cvt_pk_bf16_f32 v34, v48, v49
v_cvt_pk_bf16_f32 v35, v50, v51
v_mfma_f32_16x16x32_bf16 v[60:63], v[20:23], v[28:31], 0
s_nop 0
v_mfma_f32_16x16x32_bf16 v[60:63], v[24:27], v[32:35], v[60:63]
v_mfma_f32_16x16x32_bf16 v[36:39], v[20:23], v[96:99], 0
v_mfma_f32_16x16x32_bf16 v[40:43], v[20:23], v[104:107], 0
v_mfma_f32_16x16x32_bf16 v[44:47], v[20:23], v[112:115], 0
v_mfma_f32_16x16x32_bf16 v[48:51], v[20:23], v[120:123], 0
v_mfma_f32_16x16x32_bf16 v[36:39], v[24:27], v[100:103], v[36:39]
v_mfma_f32_16x16x32_bf16 v[40:43], v[24:27], v[108:111], v[40:43]
v_mfma_f32_16x16x32_bf16 v[44:47], v[24:27], v[116:119], v[44:47]
v_mfma_f32_16x16x32_bf16 v[48:51], v[24:27], v[124:127], v[48:51]
s_waitcnt lgkmcnt(0)
v_lshl_add_u32 v5, v58, 7, v4
v_pk_mul_f32 v[60:61], v[60:61], v[52:53]
v_pk_mul_f32 v[62:63], v[62:63], v[54:55]
s_nop 0
v_cvt_pk_bf16_f32 v20, v36, v37
v_cvt_pk_bf16_f32 v21, v38, v39
v_cvt_pk_bf16_f32 v24, v40, v41
v_cvt_pk_bf16_f32 v25, v42, v43
v_cvt_pk_bf16_f32 v28, v44, v45
v_cvt_pk_bf16_f32 v29, v46, v47
v_cvt_pk_bf16_f32 v32, v48, v49
v_cvt_pk_bf16_f32 v33, v50, v51
v_add_u32 v34, s62, v11
ds_read_b64_tr_b16 v[22:23], v34 offset:0
ds_read_b64_tr_b16 v[26:27], v34 offset:8
ds_read_b64_tr_b16 v[30:31], v34 offset:16
ds_read_b64_tr_b16 v[34:35], v34 offset:24
v_max3_f32 v58, v60, v61, v62
v_max_f32 v58, v58, v63
v_mov_b32 v59, v58
s_nop 1
v_permlane16_swap_b32 v58, v59
v_max_f32 v58, v58, v59
v_mul_f32 v58, v56, v58
v_pk_fma_f32 v[60:61], v[60:61], v[56:57], v[58:59] op_sel_hi:[1,0,0] neg_lo:[0,0,1] neg_hi:[0,0,1]
v_pk_fma_f32 v[62:63], v[62:63], v[56:57], v[58:59] op_sel_hi:[1,0,0] neg_lo:[0,0,1] neg_hi:[0,0,1]
v_exp_f32 v60, v60
v_exp_f32 v61, v61
v_exp_f32 v62, v62
v_exp_f32 v63, v63
s_nop 0
v_pk_add_f32 v[58:59], v[60:61], v[62:63]
v_add_f32 v58, v58, v59
v_mov_b32 v59, v58
s_nop 1
v_permlane16_swap_b32 v58, v59
v_add_f32 v58, v58, v59
v_rcp_f32 v58, v58
s_nop 0
v_cndmask_b32 v58, 0, v58, s[78:79]
v_pk_mul_f32 v[52:53], v[52:53], v[58:59] op_sel_hi:[1,0]
v_pk_mul_f32 v[54:55], v[54:55], v[58:59] op_sel_hi:[1,0]
v_pk_mul_f32 v[60:61], v[60:61], v[52:53]
v_pk_mul_f32 v[62:63], v[62:63], v[54:55]
v_cvt_pk_bf16_f32 v6, v60, v61
v_cvt_pk_bf16_f32 v7, v62, v63
s_waitcnt lgkmcnt(0)
s_nop 0
v_mfma_f32_16x16x32_bf16 v[36:39], v[20:23], v[6:9], 0
v_mfma_f32_16x16x32_bf16 v[40:43], v[24:27], v[6:9], 0
v_mfma_f32_16x16x32_bf16 v[44:47], v[28:31], v[6:9], 0
v_mfma_f32_16x16x32_bf16 v[48:51], v[32:35], v[6:9], 0
s_nop 4
v_cvt_pk_bf16_f32 v52, v36, v37
v_cvt_pk_bf16_f32 v53, v38, v39
v_cvt_pk_bf16_f32 v54, v40, v41
v_cvt_pk_bf16_f32 v55, v42, v43
v_cvt_pk_bf16_f32 v56, v44, v45
v_cvt_pk_bf16_f32 v57, v46, v47
v_cvt_pk_bf16_f32 v58, v48, v49
v_cvt_pk_bf16_f32 v59, v50, v51
v_mfma_f32_16x16x32_bf16 v[36:39], v[6:9], v[20:23], 0
v_mfma_f32_16x16x32_bf16 v[40:43], v[6:9], v[24:27], 0
v_mfma_f32_16x16x32_bf16 v[44:47], v[6:9], v[28:31], 0
v_mfma_f32_16x16x32_bf16 v[48:51], v[6:9], v[32:35], 0
v_mfma_f32_16x16x32_bf16 v[60:63], v[12:15], v[52:55], 0
v_mfma_f32_16x16x32_bf16 v[60:63], v[16:19], v[56:59], v[60:63]
v_dot2_f32_bf16 v6, v52, v52, 0
v_dot2_f32_bf16 v7, v53, v53, 0
v_dot2_f32_bf16 v6, v54, v54, v6
v_dot2_f32_bf16 v7, v55, v55, v7
v_dot2_f32_bf16 v6, v56, v56, v6
v_dot2_f32_bf16 v7, v57, v57, v7
v_dot2_f32_bf16 v6, v58, v58, v6
v_dot2_f32_bf16 v7, v59, v59, v7
s_nop 2
v_add_f32 v20, v6, v7
v_mov_b32 v21, v20
s_nop 1
v_permlane16_swap_b32 v20, v21
v_add_f32 v20, v20, v21
v_mov_b32 v21, v20
s_nop 1
v_permlane32_swap_b32 v20, v21
v_add_f32 v20, v20, v21
v_mul_f32 v22, s80, v60
v_mul_f32 v23, v22, v22
v_fma_f32 v20, v20, s80, -v23
v_max_f32 v20, 0, v20
v_add_f32 v20, s81, v20
v_rsq_f32 v24, v20
v_fma_f32 v25, -v22, s86, v61
v_mul_f32 v25, s83, v25
v_mul_f32 v20, v24, v25
s_nop 1
v_max_f32_dpp v21, v20, v20 quad_perm:[1,0,3,2] row_mask:0xf bank_mask:0xf
s_nop 1
v_max_f32_dpp v21, v21, v21 quad_perm:[2,3,0,1] row_mask:0xf bank_mask:0xf
s_nop 1
v_max_f32_dpp v21, v21, v21 row_half_mirror row_mask:0xf bank_mask:0xf
v_sub_f32 v20, v20, v21
v_exp_f32 v20, v20
s_nop 1
v_add_f32_dpp v21, v20, v20 quad_perm:[1,0,3,2] row_mask:0xf bank_mask:0xf
s_nop 1
v_add_f32_dpp v21, v21, v21 quad_perm:[2,3,0,1] row_mask:0xf bank_mask:0xf
s_nop 1
v_add_f32_dpp v21, v21, v21 row_half_mirror row_mask:0xf bank_mask:0xf
v_rcp_f32 v21, v21
s_nop 0
v_mul_f32 v20, v20, v21
v_and_b32 v21, s82, v20
v_sub_f32 v20, v20, v21
v_cvt_pk_bf16_f32 v22, v21, v20
v_mov_b32 v23, 0
s_nop 1
v_mfma_f32_16x16x16_bf16 v[60:63], v[22:23], v[10:11], 0
s_nop 7
v_pk_mul_f32 v[36:37], v[36:37], v[60:61]
v_pk_fma_f32 v[36:37], v[38:39], v[62:63], v[36:37]
v_add_f32 v36, v36, v37
v_pk_mul_f32 v[40:41], v[40:41], v[60:61]
v_pk_fma_f32 v[40:41], v[42:43], v[62:63], v[40:41]
v_add_f32 v40, v40, v41
v_pk_mul_f32 v[44:45], v[44:45], v[60:61]
v_pk_fma_f32 v[44:45], v[46:47], v[62:63], v[44:45]
v_add_f32 v44, v44, v45
v_pk_mul_f32 v[48:49], v[48:49], v[60:61]
v_pk_fma_f32 v[48:49], v[50:51], v[62:63], v[48:49]
v_add_f32 v48, v48, v49
v_permlane16_swap_b32 v36, v40
s_nop 0
v_permlane16_swap_b32 v44, v48
v_add_f32 v36, v36, v40
v_add_f32 v44, v44, v48
v_cvt_pk_bf16_f32 v36, v36, v44
buffer_store_short v36, v5, s[44:47], s84 offen
buffer_store_short_d16_hi v36, v5, s[44:47], s84 offen offset:16
s_branch F_NEXT
F_DONE:
s_branch P_END
P_SLOWG:
v_lshrrev_b32 v21, 3, v1
s_lshl_b32 s62, s3, 5
s_add_u32 s62, s62, 18752
v_lshl_add_u32 v39, v21, 2, s62
ds_read_b32 v40, v39
s_lshl_b32 s62, s3, 3
v_add_u32 v21, s62, v21
s_mul_i32 s62, s2, 100
s_movk_i32 s63, 100
v_cmp_gt_u32 vcc, s63, v21
v_mov_b32 v12, 0
v_mov_b32 v13, 0
v_mov_b32 v14, 0
v_mov_b32 v15, 0
v_mov_b32 v16, 0
v_mov_b32 v17, 0
v_mov_b32 v18, 0
v_mov_b32 v19, 0
v_lshlrev_b32 v41, 4, v1
s_mov_b32 s80, s6
s_mov_b32 s81, s7
s_mov_b32 s82, 3200000
s_mov_b32 s83, 0x00020000
s_mov_b32 s84, s8
s_mov_b32 s85, s9
s_mov_b32 s86, 3200000
s_mov_b32 s87, 0x00020000
s_waitcnt lgkmcnt(0)
v_add_u32 v40, s62, v40
v_cndmask_b32 v40, -1, v40, vcc
s_mov_b32 s66, 0
SG_CHUNK:
buffer_load_dwordx4 v[44:47], v41, s[84:87], s66 offen
buffer_load_dwordx4 v[48:51], v41, s[80:83], s66 offen
s_waitcnt vmcnt(0)
s_mov_b32 s67, 0
SG_R0:
v_readlane_b32 s68, v40, s67
s_mov_b64 s[62:63], 0xff
s_lshl_b64 s[62:63], s[62:63], s67
v_cmp_eq_u32 s[64:65], s68, v44
SG_E0:
s_cmp_eq_u64 s[64:65], 0
s_cbranch_scc1 SG_N0
s_ff1_i32_b64 s69, s[64:65]
s_bitset0_b64 s[64:65], s69
v_readlane_b32 s68, v48, s69
s_lshl_b32 s68, s68, 7
s_nop 0
v_add_u32 v42, s68, v2
v_mov_b32 v43, 0x7ffffff0
v_cndmask_b32 v42, v43, v42, s[62:63]
SG_P0:
buffer_load_dwordx4 v[52:55], v42, s[24:27], 0 offen sc1
s_waitcnt vmcnt(0)
v_max3_u32 v21, v52, v53, v54
v_max_u32 v21, v21, v55
v_cmp_eq_u32 vcc, -1, v21
s_cbranch_vccz SG_A0
s_add_u32 s73, s73, 1
s_cmp_gt_u32 s73, 200000
s_cbranch_scc1 SG_A0
s_sleep 8
s_branch SG_P0
SG_A0:
v_mfma_f32_16x16x32_bf16 v[12:15], v[4:7], v[52:55], v[12:15]
v_mfma_f32_16x16x32_bf16 v[16:19], v[8:11], v[52:55], v[16:19]
s_branch SG_E0
SG_N0:
s_add_u32 s67, s67, 8
s_cmp_lt_u32 s67, 64
s_cbranch_scc1 SG_R0
s_mov_b32 s67, 0
SG_R1:
v_readlane_b32 s68, v40, s67
s_mov_b64 s[62:63], 0xff
s_lshl_b64 s[62:63], s[62:63], s67
v_cmp_eq_u32 s[64:65], s68, v45
SG_E1:
s_cmp_eq_u64 s[64:65], 0
s_cbranch_scc1 SG_N1
s_ff1_i32_b64 s69, s[64:65]
s_bitset0_b64 s[64:65], s69
v_readlane_b32 s68, v49, s69
s_lshl_b32 s68, s68, 7
s_nop 0
v_add_u32 v42, s68, v2
v_mov_b32 v43, 0x7ffffff0
v_cndmask_b32 v42, v43, v42, s[62:63]
SG_P1:
buffer_load_dwordx4 v[52:55], v42, s[24:27], 0 offen sc1
s_waitcnt vmcnt(0)
v_max3_u32 v21, v52, v53, v54
v_max_u32 v21, v21, v55
v_cmp_eq_u32 vcc, -1, v21
s_cbranch_vccz SG_A1
s_add_u32 s73, s73, 1
s_cmp_gt_u32 s73, 200000
s_cbranch_scc1 SG_A1
s_sleep 8
s_branch SG_P1
SG_A1:
v_mfma_f32_16x16x32_bf16 v[12:15], v[4:7], v[52:55], v[12:15]
v_mfma_f32_16x16x32_bf16 v[16:19], v[8:11], v[52:55], v[16:19]
s_branch SG_E1
SG_N1:
s_add_u32 s67, s67, 8
s_cmp_lt_u32 s67, 64
s_cbranch_scc1 SG_R1
s_mov_b32 s67, 0
SG_R2:
v_readlane_b32 s68, v40, s67
s_mov_b64 s[62:63], 0xff
s_lshl_b64 s[62:63], s[62:63], s67
v_cmp_eq_u32 s[64:65], s68, v46
SG_E2:
s_cmp_eq_u64 s[64:65], 0
s_cbranch_scc1 SG_N2
s_ff1_i32_b64 s69, s[64:65]
s_bitset0_b64 s[64:65], s69
v_readlane_b32 s68, v50, s69
s_lshl_b32 s68, s68, 7
s_nop 0
v_add_u32 v42, s68, v2
v_mov_b32 v43, 0x7ffffff0
v_cndmask_b32 v42, v43, v42, s[62:63]
SG_P2:
buffer_load_dwordx4 v[52:55], v42, s[24:27], 0 offen sc1
s_waitcnt vmcnt(0)
v_max3_u32 v21, v52, v53, v54
v_max_u32 v21, v21, v55
v_cmp_eq_u32 vcc, -1, v21
s_cbranch_vccz SG_A2
s_add_u32 s73, s73, 1
s_cmp_gt_u32 s73, 200000
s_cbranch_scc1 SG_A2
s_sleep 8
s_branch SG_P2
SG_A2:
v_mfma_f32_16x16x32_bf16 v[12:15], v[4:7], v[52:55], v[12:15]
v_mfma_f32_16x16x32_bf16 v[16:19], v[8:11], v[52:55], v[16:19]
s_branch SG_E2
SG_N2:
s_add_u32 s67, s67, 8
s_cmp_lt_u32 s67, 64
s_cbranch_scc1 SG_R2
s_mov_b32 s67, 0
SG_R3:
v_readlane_b32 s68, v40, s67
s_mov_b64 s[62:63], 0xff
s_lshl_b64 s[62:63], s[62:63], s67
v_cmp_eq_u32 s[64:65], s68, v47
SG_E3:
s_cmp_eq_u64 s[64:65], 0
s_cbranch_scc1 SG_N3
s_ff1_i32_b64 s69, s[64:65]
s_bitset0_b64 s[64:65], s69
v_readlane_b32 s68, v51, s69
s_lshl_b32 s68, s68, 7
s_nop 0
v_add_u32 v42, s68, v2
v_mov_b32 v43, 0x7ffffff0
v_cndmask_b32 v42, v43, v42, s[62:63]
SG_P3:
buffer_load_dwordx4 v[52:55], v42, s[24:27], 0 offen sc1
s_waitcnt vmcnt(0)
v_max3_u32 v21, v52, v53, v54
v_max_u32 v21, v21, v55
v_cmp_eq_u32 vcc, -1, v21
s_cbranch_vccz SG_A3
s_add_u32 s73, s73, 1
s_cmp_gt_u32 s73, 200000
s_cbranch_scc1 SG_A3
s_sleep 8
s_branch SG_P3
SG_A3:
v_mfma_f32_16x16x32_bf16 v[12:15], v[4:7], v[52:55], v[12:15]
v_mfma_f32_16x16x32_bf16 v[16:19], v[8:11], v[52:55], v[16:19]
s_branch SG_E3
SG_N3:
s_add_u32 s67, s67, 8
s_cmp_lt_u32 s67, 64
s_cbranch_scc1 SG_R3
s_add_u32 s66, s66, 1024
s_cmp_lt_u32 s66, 3200000
s_cbranch_scc1 SG_CHUNK
s_branch P_FLUSH
F_HELP:
s_waitcnt vmcnt(0)
s_cmp_lg_u32 s3, 15
s_cbranch_scc1 LC_D
v_lshlrev_b32 v99, 4, v1
s_mov_b32 s65, 0x2800000
buffer_load_dwordx4 v[20:23], v99, s[20:23], s65 offen
s_add_u32 s65, s65, 1024
buffer_load_dwordx4 v[24:27], v99, s[20:23], s65 offen
s_add_u32 s65, s65, 1024
buffer_load_dwordx4 v[28:31], v99, s[20:23], s65 offen
s_add_u32 s65, s65, 1024
buffer_load_dwordx4 v[32:35], v99, s[20:23], s65 offen
s_add_u32 s65, s65, 1024
buffer_load_dwordx4 v[36:39], v99, s[20:23], s65 offen
s_add_u32 s65, s65, 1024
buffer_load_dwordx4 v[40:43], v99, s[20:23], s65 offen
s_add_u32 s65, s65, 1024
buffer_load_dwordx4 v[44:47], v99, s[20:23], s65 offen
s_add_u32 s65, s65, 1024
buffer_load_dwordx4 v[48:51], v99, s[20:23], s65 offen
s_add_u32 s65, s65, 1024
buffer_load_dwordx4 v[52:55], v99, s[20:23], s65 offen
s_add_u32 s65, s65, 1024
s_waitcnt vmcnt(0)
ds_write_b128 v99, v[20:23] offset:19904
ds_write_b128 v99, v[24:27] offset:20928
ds_write_b128 v99, v[28:31] offset:21952
ds_write_b128 v99, v[32:35] offset:22976
ds_write_b128 v99, v[36:39] offset:24000
ds_write_b128 v99, v[40:43] offset:25024
ds_write_b128 v99, v[44:47] offset:26048
ds_write_b128 v99, v[48:51] offset:27072
ds_write_b128 v99, v[52:55] offset:28096
s_waitcnt lgkmcnt(0)
buffer_load_dwordx4 v[20:23], v99, s[20:23], s65 offen
s_add_u32 s65, s65, 1024
buffer_load_dwordx4 v[24:27], v99, s[20:23], s65 offen
s_add_u32 s65, s65, 1024
buffer_load_dwordx4 v[28:31], v99, s[20:23], s65 offen
s_add_u32 s65, s65, 1024
buffer_load_dwordx4 v[32:35], v99, s[20:23], s65 offen
s_add_u32 s65, s65, 1024
buffer_load_dwordx4 v[36:39], v99, s[20:23], s65 offen
s_add_u32 s65, s65, 1024
buffer_load_dwordx4 v[40:43], v99, s[20:23], s65 offen
s_add_u32 s65, s65, 1024
buffer_load_dwordx4 v[44:47], v99, s[20:23], s65 offen
s_add_u32 s65, s65, 1024
buffer_load_dwordx4 v[48:51], v99, s[20:23], s65 offen
s_add_u32 s65, s65, 1024
buffer_load_dwordx4 v[52:55], v99, s[20:23], s65 offen
s_add_u32 s65, s65, 1024
s_waitcnt vmcnt(0)
ds_write_b128 v99, v[20:23] offset:29120
ds_write_b128 v99, v[24:27] offset:30144
ds_write_b128 v99, v[28:31] offset:31168
ds_write_b128 v99, v[32:35] offset:32192
ds_write_b128 v99, v[36:39] offset:33216
ds_write_b128 v99, v[40:43] offset:34240
ds_write_b128 v99, v[44:47] offset:35264
ds_write_b128 v99, v[48:51] offset:36288
ds_write_b128 v99, v[52:55] offset:37312
s_waitcnt lgkmcnt(0)
s_mov_b64 exec, 1
buffer_load_dwordx4 v[20:23], v99, s[20:23], s65 offen
s_waitcnt vmcnt(0)
ds_write_b128 v99, v[20:23] offset:38336
s_mov_b64 exec, -1
v_lshrrev_b32 v92, 4, v1
v_and_b32 v93, 15, v1
v_lshrrev_b32 v94, 3, v93
v_and_b32 v95, 7, v93
s_movk_i32 s63, 144
v_mul_u32_u24 v80, s63, v95
v_lshl_add_u32 v80, v92, 5, v80
s_movk_i32 s62, 1152
v_mad_u32_u24 v80, v94, s62, v80
v_add_u32 v80, 44752, v80
v_lshlrev_b32 v81, 2, v93
v_add_u32 v81, 41424, v81
v_lshlrev_b32 v82, 4, v92
v_add_u32 v82, 41424, v82
v_lshrrev_b32 v96, 1, v92
v_lshlrev_b32 v83, 2, v96
v_add_u32 v83, 18752, v83
v_lshrrev_b32 v97, 2, v93
v_and_b32 v98, 3, v93
v_cmp_eq_u32 s[64:65], v97, v92
v_and_b32 v99, 1, v98
v_lshlrev_b32 v99, 4, v99
v_mov_b32 v100, 0x3f80
v_lshlrev_b32 v100, v99, v100
v_cndmask_b32 v100, 0, v100, s[64:65]
v_cmp_gt_u32 vcc, 2, v98
s_nop 1
v_cndmask_b32 v88, 0, v100, vcc
v_cndmask_b32 v89, v100, 0, vcc
v_mov_b32 v90, 0x3e803e80
v_lshrrev_b32 v99, 2, v1
v_lshrrev_b32 v100, 5, v1
v_and_b32 v99, 7, v99
v_mul_u32_u24 v91, s63, v99
v_mad_u32_u24 v91, v100, s62, v91
v_and_b32 v99, 3, v1
v_lshl_add_u32 v91, v99, 5, v91
v_add_u32 v91, 44752, v91
v_lshl_add_u32 v99, v97, 4, v98
v_and_b32 v100, 1, v92
v_lshl_add_u32 v99, v100, 2, v99
v_lshlrev_b32 v84, 1, v99
v_mov_b32 v85, 0
v_mov_b32 v86, 0
v_mov_b32 v87, 0
v_lshlrev_b32 v99, 4, v1
ds_write_b128 v99, v[80:83] offset:38352
ds_write_b128 v99, v[84:87] offset:39376
ds_write_b128 v99, v[88:91] offset:40400
v_mov_b32 v99, 19876
v_mov_b32 v100, 0x8000
s_mov_b64 exec, 1
ds_or_b32 v99, v100
s_mov_b64 exec, -1
LC_D:
s_branch F_SETUP
P_END:
s_endpgm
TEXT_END:
.section .rodata,"a"
.p2align 6
.amdhsa_kernel bin_kernel
  .amdhsa_next_free_vgpr 96
  .amdhsa_next_free_sgpr 64
  .amdhsa_accum_offset 96
  .amdhsa_group_segment_fixed_size 0
  .amdhsa_kernarg_size 96
  .amdhsa_user_sgpr_count 2
  .amdhsa_user_sgpr_kernarg_segment_ptr 1
  .amdhsa_system_sgpr_workgroup_id_x 1
.end_amdhsa_kernel
.text
.section .rodata,"a"
.p2align 6
.amdhsa_kernel graph_kernel
  .amdhsa_next_free_vgpr 128
  .amdhsa_next_free_sgpr 100
  .amdhsa_accum_offset 128
  .amdhsa_group_segment_fixed_size 0
  .amdhsa_kernarg_size 96
  .amdhsa_user_sgpr_count 2
  .amdhsa_user_sgpr_kernarg_segment_ptr 1
  .amdhsa_system_sgpr_workgroup_id_x 1
.end_amdhsa_kernel
.text
```
